```python
import torch

def _softmax(x, axis=-1):
    return torch.softmax(x, dim=axis)
def _gelu(x):
    return torch.nn.functional.gelu(x, approximate="tanh")
def _silu(x):
    return torch.nn.functional.silu(x)
def _sigmoid(x):
    return torch.sigmoid(x)
def _layernorm(x, axis=-1, eps=1e-5):
    m = x.mean(dim=axis, keepdim=True)
    v = x.var(dim=axis, keepdim=True, unbiased=False)
    return (x - m) / torch.sqrt(v + eps)
def _scatter_add(tgt, idx, src, axis=0):
    return tgt.clone().index_add_(axis, idx, src)
def _segment_sum(src, seg, n):
    out = torch.zeros((n,) + src.shape[1:], dtype=src.dtype)
    return out.index_add_(0, seg, src)
def _pad(x, pw):
    flat = tuple(v for pair in reversed(pw) for v in pair)
    return torch.nn.functional.pad(x, flat)

kernel_name = 'sequential_preLN__sliding_block_cached__glu_gated_bilinear__decode'

def setup_inputs():

    _w = (lambda a: (lambda t: t.to(torch.bfloat16) if t.is_floating_point() else t)(torch.as_tensor(a)))
    def _A_setup():
        B, Sq, D = 2, 1, 512
        Hq, Hkv, Sk, Dh = 32, 8, 32768, 128
        assert Hq % Hkv == 0, (Hq, Hkv)
        return {
            "x": _w((lambda *s: torch.randn(*s, dtype=torch.bfloat16) * 0.05)(B, Sq, D)),
            "k_cache": _w((lambda *s: torch.randn(*s, dtype=torch.bfloat16) * 1.6)(B, Hkv, Sk, Dh)),
            "v_cache": _w((lambda *s: torch.randn(*s, dtype=torch.bfloat16) * 0.8)(B, Hkv, Sk, Dh)),
            "wq": _w((lambda *s: torch.randn(*s, dtype=torch.bfloat16) * 1.6)(D, Hq * Dh) * (D ** -0.5)),
            "wo": _w((lambda *s: torch.randn(*s, dtype=torch.bfloat16) * 0.8)(Hq * Dh, D) * ((Hq * Dh) ** -0.5)),
        }
    _A_in = _A_setup()

    def _B_setup():
        B, S, D, F = 2, 1, 512, 1792
        return {
            "x": _w((lambda *s: torch.randn(*s, dtype=torch.bfloat16) * 0.05)(B, S, D)),
            "w_gate": _w((lambda *s: torch.randn(*s, dtype=torch.bfloat16) * 0.4)(D, F) * (D ** -0.5)),
            "w_up": _w((lambda *s: torch.randn(*s, dtype=torch.bfloat16) * 0.4)(D, F) * (D ** -0.5)),
            "w_down": _w((lambda *s: torch.randn(*s, dtype=torch.bfloat16) * 0.4)(F, D) * (F ** -0.5)),
        }
    _B_in = _B_setup()

    return {
        "A_x": _A_in["x"],
        "A_k_cache": _A_in["k_cache"],
        "A_v_cache": _A_in["v_cache"],
        "A_wq": _A_in["wq"],
        "A_wo": _A_in["wo"],
        "B_x": _B_in["x"],
        "B_w_gate": _B_in["w_gate"],
        "B_w_up": _B_in["w_up"],
        "B_w_down": _B_in["w_down"],
    }

def reference(A_x, A_k_cache, A_v_cache, A_wq, A_wo, B_x, B_w_gate, B_w_up, B_w_down):
    def _A_ref(x, k_cache, v_cache, wq, wo):
        B, Sq, D = x.shape
        Hq, Dh = 32, 128
        Hkv, Sk = k_cache.shape[1], k_cache.shape[2]
        W = min(4096, max(256, Sk // 4))
        rep = Hq // Hkv
        q = (lambda x, *d: x.permute(*d))((x @ wq).reshape(B, Sq, Hq, Dh), 0, 2, 1, 3)
        k = (lambda x, n, axis: torch.repeat_interleave(x, n, dim=axis))(k_cache[:, :, Sk - W:, :], rep, axis=1)
        v = (lambda x, n, axis: torch.repeat_interleave(x, n, dim=axis))(v_cache[:, :, Sk - W:, :], rep, axis=1)
        scores = torch.einsum("bhqd,bhkd->bhqk", q, k) * (Dh ** -0.5)
        p = _softmax(scores, axis=-1)
        o = torch.einsum("bhqk,bhkd->bhqd", p, v)
        return (lambda x, *d: x.permute(*d))(o, 0, 2, 1, 3).reshape(B, Sq, Hq * Dh) @ wo

    def _B_ref(x, w_gate, w_up, w_down):
        g = torch.einsum("bsd,df->bsf", x, w_gate)
        u = torch.einsum("bsd,df->bsf", x, w_up)
        h = g * u
        return torch.einsum("bsf,fd->bsd", h, w_down)

    x = A_x
    h = x + _A_ref(_layernorm(x, axis=-1), A_k_cache, A_v_cache, A_wq, A_wo)
    h2 = h + _B_ref(_layernorm(h, axis=-1), B_w_gate, B_w_up, B_w_down)
    return h2
```

```asm
; @launch grid=(256,1,1) block=(512,1,1) lds=159744
.amdgcn_target "amdgcn-amd-amdhsa--gfx950"
.text
.globl sequential_preLN__sliding_block_cached__glu_gated_bilinear__decode_kernel
.p2align 8
.type sequential_preLN__sliding_block_cached__glu_gated_bilinear__decode_kernel,@function
sequential_preLN__sliding_block_cached__glu_gated_bilinear__decode_kernel:
    s_cmp_ge_u32 s2, 256
    s_cbranch_scc1 L_end
    s_load_dwordx16 s[4:19], s[0:1], 0
    s_load_dwordx8 s[20:27], s[0:1], 64
    s_memrealtime s[98:99]
    v_lshrrev_b32 v2, 6, v0
    v_and_b32 v1, 63, v0
    v_readfirstlane_b32 s68, v2
    s_lshr_b32 s70, s2, 3
    s_and_b32 s69, s2, 7
    s_lshr_b32 s71, s2, 7
    v_lshlrev_b32 v5, 4, v1
    s_cmp_lt_u32 s68, 2
    s_cbranch_scc1 L_w01
    v_mov_b64 v[14:15], 0
    v_lshlrev_b32 v3, 3, v1
    ds_write_b64 v3, v[14:15] offset:768
    s_cmp_lg_u32 s68, 7
    s_cbranch_scc1 L_nocpf
    s_sub_u32 s78, s70, 16
    s_cmp_ge_u32 s78, 3
    s_cbranch_scc1 L_nocpf
    s_getpc_b64 s[100:101]
    v_lshlrev_b32 v3, 7, v1
    global_load_dword v254, v3, s[100:101]
    v_add_u32 v3, 0x2000, v3
    v_min_u32 v3, 0x3bdc, v3
    global_load_dword v255, v3, s[100:101]
L_nocpf:
    s_xor_b32 s80, s68, s70
    s_lshr_b32 s78, s2, 6
    s_lshl_b32 s78, s78, 14
    s_bfe_u32 s97, s2, 0x60000
    s_lshl_b32 s97, s97, 7
    s_add_u32 s78, s78, s97
    s_bfe_u32 s97, s80, 0x10000
    s_lshl_b32 s97, s97, 13
    s_add_u32 s78, s78, s97
    s_add_u32 s78, s78, 0xe0000
    s_lshr_b32 s79, s68, 1
    s_cmp_eq_u32 s79, 2
    s_waitcnt lgkmcnt(0)
    s_cbranch_scc0 L_noprb0
    s_memtime s[86:87]
    s_load_dword s79, s[26:27], s78
L_noprb0:
    s_barrier
    s_cbranch_scc0 L_other
    s_waitcnt lgkmcnt(0)
    s_memtime s[84:85]
    s_branch L_other
L_w01:
    s_cmp_eq_u32 s68, 1
    s_cbranch_scc1 L_loader
    s_bfe_u32 s84, s70, 0x20002
    s_lshl_b32 s84, s84, 8
    v_and_b32 v6, 0x1ff, v5
    v_add_u32 v6, s84, v6
    v_and_b32 v6, 0x3ff, v6
    v_and_b32 v7, 32, v1
    v_lshl_or_b32 v6, v7, 5, v6
    v_xor_b32 v7, 0x200, v6
    s_waitcnt lgkmcnt(0)
    s_mov_b32 s3, s98
    s_mov_b32 s28, s4
    s_and_b32 s29, s5, 0xffff
    s_mov_b32 s30, 0x800
    s_mov_b32 s31, 0x20000
    buffer_load_dwordx4 v[240:243], v6, s[28:31], 0 offen
    buffer_load_dwordx4 v[244:247], v7, s[28:31], 0 offen
    s_barrier
    s_branch L_qwave
L_loader:
    v_bfe_u32 v6, v1, 3, 3
    v_lshlrev_b32 v6, 13, v6
    v_bfe_u32 v2, v1, 0, 3
    v_lshl_or_b32 v6, v2, 4, v6
    v_bfe_u32 v7, v1, 4, 1
    v_lshlrev_b32 v7, 5, v7
    v_xor_b32 v6, v6, v7
    v_xor_b32 v7, 64, v6
    v_add_u32 v7, 0xfc00, v7
    v_add_u32 v8, 0x1f800, v6
    v_add_u32 v9, 0x1f800, v7
    s_xor_b32 s72, s70, 16
    s_lshl_b32 s78, s69, 10
    s_bfe_u32 s97, s70, 0x20000
    s_lshl_b32 s97, s97, 7
    s_add_u32 s78, s78, s97
    s_lshr_b32 s97, s72, 4
    s_lshl_b32 s97, s97, 9
    s_add_u32 s78, s78, s97
    s_bfe_u32 s97, s70, 0x20002
    s_lshl_b32 s97, s97, 20
    s_add_u32 s78, s78, s97
    s_mov_b32 m0, 0x3000
    s_waitcnt lgkmcnt(0)
    s_mov_b32 s40, s10
    s_and_b32 s41, s11, 0xffff
    s_mov_b32 s42, 0x400000
    s_mov_b32 s43, 0x20000
    s_barrier
L_wq:
    buffer_load_dwordx4 v6, s[40:43], s78 offen offset:0 nt lds
    buffer_load_dwordx4 v7, s[40:43], s78 offen offset:1024 nt lds
    buffer_load_dwordx4 v8, s[40:43], s78 offen offset:2048 nt lds
    buffer_load_dwordx4 v9, s[40:43], s78 offen offset:3072 nt lds
    s_add_u32 m0, m0, 4096
    s_add_u32 s78, s78, 0x40000
    s_cmp_lg_u32 m0, 0x7000
    s_cbranch_scc1 L_wq
    s_mov_b32 s3, s98
    v_bfe_u32 v6, v1, 4, 2
    v_lshlrev_b32 v6, 4, v6
    v_xor_b32 v6, v5, v6
    v_xor_b32 v7, 64, v6
    v_xor_b32 v8, 128, v6
    v_xor_b32 v9, 192, v6
    s_lshl_b32 s78, s71, 26
    s_lshl_b32 s97, s69, 23
    s_add_u32 s78, s78, s97
    s_bfe_u32 s97, s70, 0x40000
    s_lshl_b32 s97, s97, 16
    s_add_u32 s78, s78, s97
    s_add_u32 s78, s78, 0x700000
    s_mov_b32 s80, s70
    s_mov_b32 s32, s6
    s_and_b32 s33, s7, 0xffff
    s_mov_b32 s34, 0x8000000
    s_mov_b32 s35, 0x20000
    v_mov_b32 v14, 0
    v_mov_b32 v3, 4
    s_add_u32 s81, s3, 125
    s_mul_i32 s79, s71, 30
    s_add_u32 s81, s81, s79
    s_sub_u32 s84, s3, 1000
    s_mov_b32 s93, s84
    s_mov_b32 s92, 3
    s_cmp_ge_u32 s70, 16
    s_cselect_b32 s72, 2, 6
    s_add_u32 s86, s3, 500
    s_branch L_ldk
L_ldk_w:
    s_memrealtime s[86:87]
    s_getreg_b32 s79, hwreg(HW_REG_IB_STS)
    s_and_b32 s79, s79, 0xc0000f
    s_sub_u32 s85, s86, s3
    s_cmp_lt_u32 s85, 140
    s_cselect_b32 s85, 7, s72
    s_cmp_gt_u32 s79, s85
    s_cselect_b32 s84, s84, s93
    s_waitcnt lgkmcnt(0)
L_ldk:
    s_sub_u32 s85, s86, s84
    s_cmp_lt_i32 s85, 0
    s_cbranch_scc1 L_ldk_w
    s_add_u32 s84, s84, 14
    s_bfe_u32 s79, s80, 0x40000
    s_lshl_b32 s79, s79, 12
    s_add_u32 s79, s79, s78
    s_add_u32 s80, s80, 1
    s_waitcnt vmcnt(27)
    buffer_load_dwordx4 v6, s[32:35], s79 offen offset:0 nt lds
    s_waitcnt vmcnt(27)
    buffer_load_dwordx4 v7, s[32:35], s79 offen offset:1024 nt lds
    s_waitcnt vmcnt(27)
    s_memrealtime s[86:87]
    buffer_load_dwordx4 v8, s[32:35], s79 offen offset:2048 nt lds
    s_waitcnt vmcnt(27)
    buffer_load_dwordx4 v9, s[32:35], s79 offen offset:3072 nt lds
    v_add_u32 v3, 4, v3
    ds_write_b32 v14, v3 offset:1036
    s_add_u32 m0, m0, 4096
    s_cmp_eq_u32 m0, 0xb000
    s_cselect_b32 s84, s81, s84
    s_cmp_lg_u32 m0, 0x17000
    s_cbranch_scc1 L_ldk
    s_memrealtime s[86:87]
    s_mov_b32 s32, s8
    s_and_b32 s33, s9, 0xffff
    v_bfe_u32 v6, v1, 4, 2
    v_lshlrev_b32 v6, 5, v6
    v_xor_b32 v6, v5, v6
    v_xor_b32 v7, 128, v6
    v_add_u32 v3, -4, v3
    s_cmp_ge_u32 s70, 16
    s_mov_b32 s85, 297
    s_cselect_b32 s85, 332, s85
    v_mov_b32 v14, 0
    s_mov_b32 s76, 0xffff0000
    s_mov_b32 s77, 0xfffffc00
    s_mov_b32 s82, 5000000
    s_mov_b32 s60, s26
    s_and_b32 s61, s27, 0xffff
    s_mov_b32 s62, 0x1000000
    s_mov_b32 s63, 0x20000
    v_bfe_u32 v240, v1, 2, 4
    v_lshlrev_b32 v240, 8, v240
    v_bfe_u32 v2, v1, 2, 3
    v_lshl_or_b32 v240, v2, 5, v240
    v_bfe_u32 v2, v1, 1, 1
    v_lshl_or_b32 v240, v2, 4, v240
    v_bfe_u32 v2, v1, 0, 1
    v_lshl_or_b32 v240, v2, 3, v240
    v_add_u32 v240, 0x1f000, v240
    v_xor_b32 v241, 32, v240
    v_xor_b32 v242, 64, v240
    v_xor_b32 v243, 96, v240
    v_xor_b32 v244, 128, v240
    v_xor_b32 v245, 160, v240
    v_xor_b32 v246, 192, v240
    v_xor_b32 v247, 224, v240
    v_bfe_u32 v4, v1, 3, 3
    v_lshlrev_b32 v4, 13, v4
    v_bfe_u32 v2, v1, 0, 3
    v_lshl_or_b32 v4, v2, 4, v4
    s_lshl_b32 s88, s69, 16
    s_lshl_b32 s97, s70, 7
    s_add_u32 s88, s88, s97
    s_add_u32 s88, s88, 0x20000
    s_add_u32 s89, s88, 4096
    s_waitcnt lgkmcnt(0)
    s_add_u32 s85, s85, s3
    s_sub_u32 s79, s84, s3
    s_cmp_ge_i32 s79, 0
    s_cselect_b32 s84, s85, s84
    s_cselect_b32 s79, 1, 2
    v_mov_b32 v13, s79
    s_branch L_ld_t
L_ld_w:
    s_memrealtime s[86:87]
    s_getreg_b32 s79, hwreg(HW_REG_IB_STS)
    s_and_b32 s79, s79, 0xc0000f
    s_cmp_gt_u32 s79, 6
    s_addc_u32 s92, s92, -1
    s_cmp_gt_i32 s92, 0
    s_cselect_b32 s84, s84, s93
    s_waitcnt lgkmcnt(0)
L_ld_t:
    s_sub_u32 s85, s86, s84
    s_cmp_lt_i32 s85, 0
    s_cbranch_scc1 L_ld_w
    s_add_u32 s84, s84, 14
    s_bfe_u32 s79, s80, 0x40000
    s_lshl_b32 s79, s79, 12
    s_add_u32 s79, s79, s78
    s_add_u32 s80, s80, 1
    s_waitcnt vmcnt(31)
    buffer_load_dwordx4 v6, s[32:35], s79 offen offset:0 nt lds
    s_waitcnt vmcnt(31)
    buffer_load_dwordx4 v7, s[32:35], s79 offen offset:1024 nt lds
    s_waitcnt vmcnt(31)
    s_memrealtime s[86:87]
    buffer_load_dwordx4 v6, s[32:35], s79 offen offset:2048 nt lds
    s_waitcnt vmcnt(31)
    buffer_load_dwordx4 v7, s[32:35], s79 offen offset:3072 nt lds
    v_add_u32 v3, 4, v3
    ds_write_b32 v14, v3 offset:1036
    s_add_u32 m0, m0, 4096
    s_cmp_lg_u32 m0, 0x27000
    s_cbranch_scc1 L_ld_t
    ds_write_b32 v14, v13 offset:1032
    s_setprio 3
L_fx_retry:
    ds_read_b128 v[176:179], v14 offset:1072
    ds_read_b32 v180, v14 offset:1024
    ds_read_b64 v[182:183], v14 offset:1232
    ds_read_b128 v[192:195], v5 offset:12288
    ds_read_b128 v[196:199], v5 offset:13312
    ds_read_b128 v[200:203], v5 offset:14336
    ds_read_b128 v[204:207], v5 offset:15360
    s_waitcnt vmcnt(24)
    ds_read_b64_tr_b16 v[16:17], v240 offset:0
    ds_read_b64_tr_b16 v[20:21], v241 offset:0
    ds_read_b64_tr_b16 v[24:25], v242 offset:0
    ds_read_b64_tr_b16 v[28:29], v243 offset:0
    ds_read_b64_tr_b16 v[32:33], v244 offset:0
    ds_read_b64_tr_b16 v[36:37], v245 offset:0
    ds_read_b64_tr_b16 v[40:41], v246 offset:0
    ds_read_b64_tr_b16 v[44:45], v247 offset:0
    ds_read_b64_tr_b16 v[18:19], v240 offset:4096
    ds_read_b64_tr_b16 v[22:23], v241 offset:4096
    ds_read_b64_tr_b16 v[26:27], v242 offset:4096
    ds_read_b64_tr_b16 v[30:31], v243 offset:4096
    ds_read_b64_tr_b16 v[34:35], v244 offset:4096
    ds_read_b64_tr_b16 v[38:39], v245 offset:4096
    ds_read_b64_tr_b16 v[42:43], v246 offset:4096
    ds_read_b64_tr_b16 v[46:47], v247 offset:4096
    s_waitcnt lgkmcnt(15)
    v_min3_u32 v176, v176, v177, v178
    v_min3_u32 v176, v176, v179, v182
    v_cmp_eq_u32 vcc, 0, v176
    s_cbranch_vccz L_fx_ok
    s_sleep 2
    s_sub_u32 s82, s82, 1
    s_cmp_ge_i32 s82, 0
    s_cbranch_scc1 L_fx_retry
L_fx_ok:
    v_readfirstlane_b32 s92, v180
    v_and_b32 v15, 0x3f8, v183
    s_waitcnt vmcnt(16)
    ds_read_b64_tr_b16 v[48:49], v240 offset:8192
    ds_read_b64_tr_b16 v[52:53], v241 offset:8192
    ds_read_b64_tr_b16 v[56:57], v242 offset:8192
    ds_read_b64_tr_b16 v[60:61], v243 offset:8192
    ds_read_b64_tr_b16 v[64:65], v244 offset:8192
    ds_read_b64_tr_b16 v[68:69], v245 offset:8192
    ds_read_b64_tr_b16 v[72:73], v246 offset:8192
    ds_read_b64_tr_b16 v[76:77], v247 offset:8192
    ds_read_b64_tr_b16 v[50:51], v240 offset:12288
    ds_read_b64_tr_b16 v[54:55], v241 offset:12288
    ds_read_b64_tr_b16 v[58:59], v242 offset:12288
    ds_read_b64_tr_b16 v[62:63], v243 offset:12288
    ds_read_b64_tr_b16 v[66:67], v244 offset:12288
    ds_read_b64_tr_b16 v[70:71], v245 offset:12288
    ds_read_b64_tr_b16 v[74:75], v246 offset:12288
    ds_read_b64_tr_b16 v[78:79], v247 offset:12288
    s_waitcnt lgkmcnt(15)
    v_mfma_f32_16x16x32_bf16 v[208:211], v[192:195], v[16:19], 0
    v_mfma_f32_16x16x32_bf16 v[212:215], v[192:195], v[20:23], 0
    v_mfma_f32_16x16x32_bf16 v[216:219], v[192:195], v[24:27], 0
    v_mfma_f32_16x16x32_bf16 v[220:223], v[192:195], v[28:31], 0
    v_mfma_f32_16x16x32_bf16 v[224:227], v[192:195], v[32:35], 0
    v_mfma_f32_16x16x32_bf16 v[228:231], v[192:195], v[36:39], 0
    v_mfma_f32_16x16x32_bf16 v[232:235], v[192:195], v[40:43], 0
    v_mfma_f32_16x16x32_bf16 v[236:239], v[192:195], v[44:47], 0
    s_waitcnt vmcnt(8)
    ds_read_b64_tr_b16 v[144:145], v240 offset:16384
    ds_read_b64_tr_b16 v[148:149], v241 offset:16384
    ds_read_b64_tr_b16 v[152:153], v242 offset:16384
    ds_read_b64_tr_b16 v[156:157], v243 offset:16384
    ds_read_b64_tr_b16 v[160:161], v244 offset:16384
    ds_read_b64_tr_b16 v[164:165], v245 offset:16384
    ds_read_b64_tr_b16 v[168:169], v246 offset:16384
    ds_read_b64_tr_b16 v[172:173], v247 offset:16384
    ds_read_b64_tr_b16 v[146:147], v240 offset:20480
    ds_read_b64_tr_b16 v[150:151], v241 offset:20480
    ds_read_b64_tr_b16 v[154:155], v242 offset:20480
    ds_read_b64_tr_b16 v[158:159], v243 offset:20480
    ds_read_b64_tr_b16 v[162:163], v244 offset:20480
    ds_read_b64_tr_b16 v[166:167], v245 offset:20480
    ds_read_b64_tr_b16 v[170:171], v246 offset:20480
    ds_read_b64_tr_b16 v[174:175], v247 offset:20480
    s_waitcnt lgkmcnt(15)
    v_mfma_f32_16x16x32_bf16 v[208:211], v[196:199], v[48:51], v[208:211]
    v_mfma_f32_16x16x32_bf16 v[212:215], v[196:199], v[52:55], v[212:215]
    v_mfma_f32_16x16x32_bf16 v[216:219], v[196:199], v[56:59], v[216:219]
    v_mfma_f32_16x16x32_bf16 v[220:223], v[196:199], v[60:63], v[220:223]
    v_mfma_f32_16x16x32_bf16 v[224:227], v[196:199], v[64:67], v[224:227]
    v_mfma_f32_16x16x32_bf16 v[228:231], v[196:199], v[68:71], v[228:231]
    v_mfma_f32_16x16x32_bf16 v[232:235], v[196:199], v[72:75], v[232:235]
    v_mfma_f32_16x16x32_bf16 v[236:239], v[196:199], v[76:79], v[236:239]
L_fp_retry:
    ds_read_b128 v[176:179], v14 offset:1040
    ds_read_b128 v[112:115], v5 offset:4096
    ds_read_b128 v[116:119], v5 offset:5120
    ds_read_b128 v[120:123], v5 offset:6144
    ds_read_b128 v[124:127], v5 offset:7168
    ds_read_b128 v[128:131], v5 offset:8192
    ds_read_b128 v[132:135], v5 offset:9216
    ds_read_b128 v[136:139], v5 offset:10240
    ds_read_b128 v[140:143], v5 offset:11264
    s_waitcnt lgkmcnt(8)
    v_min3_u32 v176, v176, v177, v178
    v_min_u32 v176, v176, v179
    v_cmp_eq_u32 vcc, 0, v176
    s_cbranch_vccz L_fp_ok
    s_sub_u32 s82, s82, 1
    s_cmp_ge_i32 s82, 0
    s_cbranch_scc1 L_fp_retry
L_fp_ok:
    v_mfma_f32_16x16x32_bf16 v[208:211], v[200:203], v[144:147], v[208:211]
    v_mfma_f32_16x16x32_bf16 v[212:215], v[200:203], v[148:151], v[212:215]
    v_mfma_f32_16x16x32_bf16 v[216:219], v[200:203], v[152:155], v[216:219]
    v_mfma_f32_16x16x32_bf16 v[220:223], v[200:203], v[156:159], v[220:223]
    v_mfma_f32_16x16x32_bf16 v[224:227], v[200:203], v[160:163], v[224:227]
    v_mfma_f32_16x16x32_bf16 v[228:231], v[200:203], v[164:167], v[228:231]
    v_mfma_f32_16x16x32_bf16 v[232:235], v[200:203], v[168:171], v[232:235]
    v_mfma_f32_16x16x32_bf16 v[236:239], v[200:203], v[172:175], v[236:239]
    s_waitcnt lgkmcnt(0)
    v_pk_add_f32 v[112:113], v[112:113], v[128:129]
    v_pk_add_f32 v[114:115], v[114:115], v[130:131]
    v_pk_add_f32 v[116:117], v[116:117], v[132:133]
    v_pk_add_f32 v[118:119], v[118:119], v[134:135]
    v_pk_add_f32 v[120:121], v[120:121], v[136:137]
    v_pk_add_f32 v[122:123], v[122:123], v[138:139]
    v_pk_add_f32 v[124:125], v[124:125], v[140:141]
    v_pk_add_f32 v[126:127], v[126:127], v[142:143]
    v_pk_add_f32 v[112:113], v[112:113], v[120:121]
    v_pk_add_f32 v[114:115], v[114:115], v[122:123]
    v_pk_add_f32 v[116:117], v[116:117], v[124:125]
    v_pk_add_f32 v[118:119], v[118:119], v[126:127]
    s_waitcnt vmcnt(4)
    ds_read_b64_tr_b16 v[16:17], v240 offset:24576
    ds_read_b64_tr_b16 v[20:21], v241 offset:24576
    ds_read_b64_tr_b16 v[24:25], v242 offset:24576
    ds_read_b64_tr_b16 v[28:29], v243 offset:24576
    ds_read_b64_tr_b16 v[32:33], v244 offset:24576
    ds_read_b64_tr_b16 v[36:37], v245 offset:24576
    ds_read_b64_tr_b16 v[40:41], v246 offset:24576
    ds_read_b64_tr_b16 v[44:45], v247 offset:24576
    v_add_f32 v208, v208, v112
    v_add_f32 v212, v212, v113
    v_add_f32 v216, v216, v114
    v_add_f32 v220, v220, v115
    v_add_f32 v224, v224, v116
    v_add_f32 v228, v228, v117
    v_add_f32 v232, v232, v118
    v_add_f32 v236, v236, v119
    s_cmp_lg_u32 s92, 2
    s_waitcnt vmcnt(0)
    ds_read_b64_tr_b16 v[18:19], v240 offset:28672
    ds_read_b64_tr_b16 v[22:23], v241 offset:28672
    ds_read_b64_tr_b16 v[26:27], v242 offset:28672
    ds_read_b64_tr_b16 v[30:31], v243 offset:28672
    ds_read_b64_tr_b16 v[34:35], v244 offset:28672
    ds_read_b64_tr_b16 v[38:39], v245 offset:28672
    ds_read_b64_tr_b16 v[42:43], v246 offset:28672
    ds_read_b64_tr_b16 v[46:47], v247 offset:28672
    s_waitcnt lgkmcnt(7)
    v_mfma_f32_16x16x32_bf16 v[208:211], v[204:207], v[16:19], v[208:211]
    s_waitcnt lgkmcnt(6)
    v_mfma_f32_16x16x32_bf16 v[212:215], v[204:207], v[20:23], v[212:215]
    s_waitcnt lgkmcnt(5)
    v_mfma_f32_16x16x32_bf16 v[216:219], v[204:207], v[24:27], v[216:219]
    s_waitcnt lgkmcnt(4)
    v_mfma_f32_16x16x32_bf16 v[220:223], v[204:207], v[28:31], v[220:223]
    s_waitcnt lgkmcnt(3)
    v_mfma_f32_16x16x32_bf16 v[224:227], v[204:207], v[32:35], v[224:227]
    s_waitcnt lgkmcnt(2)
    v_mfma_f32_16x16x32_bf16 v[228:231], v[204:207], v[36:39], v[228:231]
    s_waitcnt lgkmcnt(1)
    v_mfma_f32_16x16x32_bf16 v[232:235], v[204:207], v[40:43], v[232:235]
    s_waitcnt lgkmcnt(0)
    v_mfma_f32_16x16x32_bf16 v[236:239], v[204:207], v[44:47], v[236:239]
    v_and_or_b32 v80, v208, s77, v15
    v_and_or_b32 v81, v212, s77, v15
    v_and_or_b32 v82, v216, s77, v15
    v_and_or_b32 v83, v220, s77, v15
    v_and_or_b32 v84, v224, s77, v15
    v_and_or_b32 v85, v228, s77, v15
    v_and_or_b32 v86, v232, s77, v15
    s_nop 0
    v_and_or_b32 v87, v236, s77, v15
    s_cbranch_scc1 L_ls1
    buffer_store_dwordx4 v[80:83], v4, s[60:63], s88 offen
    buffer_store_dwordx4 v[84:87], v4, s[60:63], s89 offen
L_le1:
    ds_write_b32 v14, v13 offset:1028
    s_branch L_fin
L_qwave:
    s_load_dword s83, s[26:27], 0
    v_mov_b32 v14, 0
    s_mov_b32 s76, 0xffff0000
    s_mov_b32 s77, 0xfffffc00
    s_mov_b32 s82, 5000000
    s_mov_b32 s84, 20
    s_xor_b32 s72, s70, 16
    s_mov_b32 s60, s26
    s_and_b32 s61, s27, 0xffff
    s_mov_b32 s62, 0x1000000
    s_mov_b32 s63, 0x20000
    s_mov_b32 s44, s12
    s_and_b32 s45, s13, 0xffff
    s_mov_b32 s46, 0x400000
    s_mov_b32 s47, 0x20000
    s_mov_b32 s48, s16
    s_and_b32 s49, s17, 0xffff
    s_mov_b32 s50, 0x1c0000
    s_mov_b32 s51, 0x20000
    s_mov_b32 s52, s18
    s_and_b32 s53, s19, 0xffff
    s_mov_b32 s54, 0x1c0000
    s_mov_b32 s55, 0x20000
    s_mov_b32 s56, s20
    s_and_b32 s57, s21, 0xffff
    s_mov_b32 s58, 0x1c0000
    s_mov_b32 s59, 0x20000
    s_mov_b32 s64, s22
    s_and_b32 s65, s23, 0xffff
    s_mov_b32 s66, 0x800
    s_mov_b32 s67, 0x20000
    s_getreg_b32 s93, hwreg(HW_REG_XCC_ID, 0, 3)
    v_bfe_u32 v7, v1, 0, 1
    v_lshlrev_b32 v7, 9, v7
    v_bfe_u32 v2, v1, 4, 2
    v_lshl_or_b32 v7, v2, 4, v7
    v_bfe_u32 v8, v1, 4, 2
    v_lshlrev_b32 v8, 10, v8
    v_bfe_u32 v2, v1, 2, 2
    v_lshl_or_b32 v8, v2, 7, v8
    v_bfe_u32 v2, v1, 4, 1
    v_lshl_or_b32 v8, v2, 6, v8
    v_bfe_u32 v2, v1, 3, 1
    v_lshl_or_b32 v8, v2, 5, v8
    v_bfe_u32 v2, v1, 1, 1
    v_lshl_or_b32 v8, v2, 4, v8
    v_bfe_u32 v2, v1, 0, 1
    v_lshl_or_b32 v8, v2, 3, v8
    v_add_u32 v8, 0x3000, v8
    v_xor_b32 v9, 32, v8
    v_xor_b32 v10, 64, v8
    v_xor_b32 v11, 96, v8
    v_bfe_u32 v12, v1, 0, 1
    v_lshlrev_b32 v12, 13, v12
    v_bfe_u32 v2, v1, 4, 2
    v_lshl_or_b32 v12, v2, 4, v12
    s_lshl_b32 s88, s69, 14
    s_bfe_u32 s97, s70, 0x20002
    s_lshl_b32 s97, s97, 11
    s_add_u32 s88, s88, s97
    s_bfe_u32 s97, s70, 0x20000
    s_lshl_b32 s97, s97, 8
    s_add_u32 s88, s88, s97
    s_lshr_b32 s97, s72, 4
    s_lshl_b32 s97, s97, 10
    s_add_u32 s88, s88, s97
    s_add_u32 s88, s88, 0x1e0000
    s_lshl_b32 s81, s69, 14
    s_lshl_b32 s97, s71, 13
    s_add_u32 s81, s81, s97
    s_add_u32 s81, s81, 0x1e0000
    s_mov_b32 s89, 10
    s_mov_b32 s90, 0xff
    s_add_u32 s80, s81, 4096
    v_mov_b64 v[208:209], 0
    v_mov_b64 v[210:211], 0
    v_mov_b64 v[212:213], 0
    v_mov_b64 v[214:215], 0
    v_mov_b64 v[216:217], 0
    v_mov_b64 v[218:219], 0
    v_mov_b64 v[220:221], 0
    v_mov_b64 v[222:223], 0
    s_waitcnt vmcnt(0)
    v_lshlrev_b32 v176, 16, v240
    v_and_b32 v177, s76, v240
    v_lshlrev_b32 v178, 16, v241
    v_and_b32 v179, s76, v241
    v_lshlrev_b32 v180, 16, v242
    v_and_b32 v181, s76, v242
    v_lshlrev_b32 v182, 16, v243
    v_and_b32 v183, s76, v243
    v_lshlrev_b32 v184, 16, v244
    v_and_b32 v185, s76, v244
    v_lshlrev_b32 v186, 16, v245
    v_and_b32 v187, s76, v245
    v_lshlrev_b32 v188, 16, v246
    v_and_b32 v189, s76, v246
    v_lshlrev_b32 v190, 16, v247
    v_and_b32 v191, s76, v247
    v_pk_add_f32 v[192:193], v[176:177], v[178:179]
    v_pk_mul_f32 v[194:195], v[176:177], v[176:177]
    v_pk_add_f32 v[192:193], v[192:193], v[180:181]
    v_pk_fma_f32 v[194:195], v[178:179], v[178:179], v[194:195]
    v_pk_add_f32 v[192:193], v[192:193], v[182:183]
    v_pk_fma_f32 v[194:195], v[180:181], v[180:181], v[194:195]
    v_pk_add_f32 v[192:193], v[192:193], v[184:185]
    v_pk_fma_f32 v[194:195], v[182:183], v[182:183], v[194:195]
    v_pk_add_f32 v[192:193], v[192:193], v[186:187]
    v_pk_fma_f32 v[194:195], v[184:185], v[184:185], v[194:195]
    v_pk_add_f32 v[192:193], v[192:193], v[188:189]
    v_pk_fma_f32 v[194:195], v[186:187], v[186:187], v[194:195]
    v_pk_add_f32 v[192:193], v[192:193], v[190:191]
    v_pk_fma_f32 v[194:195], v[188:189], v[188:189], v[194:195]
    v_pk_fma_f32 v[194:195], v[190:191], v[190:191], v[194:195]
    v_add_f32 v192, v192, v193
    v_add_f32 v194, v194, v195
    s_nop 0
    v_add_f32_dpp v192, v192, v192 row_ror:1 row_mask:0xf bank_mask:0xf
    v_add_f32_dpp v194, v194, v194 row_ror:1 row_mask:0xf bank_mask:0xf
    s_nop 0
    v_add_f32_dpp v192, v192, v192 row_ror:2 row_mask:0xf bank_mask:0xf
    v_add_f32_dpp v194, v194, v194 row_ror:2 row_mask:0xf bank_mask:0xf
    s_nop 0
    v_add_f32_dpp v192, v192, v192 row_ror:4 row_mask:0xf bank_mask:0xf
    v_add_f32_dpp v194, v194, v194 row_ror:4 row_mask:0xf bank_mask:0xf
    s_nop 0
    v_add_f32_dpp v192, v192, v192 row_ror:8 row_mask:0xf bank_mask:0xf
    v_add_f32_dpp v194, v194, v194 row_ror:8 row_mask:0xf bank_mask:0xf
    v_mov_b32 v193, v192
    v_mov_b32 v195, v194
    s_nop 0
    v_permlane16_swap_b32 v192, v193
    v_permlane16_swap_b32 v194, v195
    v_add_f32 v192, v192, v193
    v_add_f32 v194, v194, v195
    v_mul_f32 v192, 0x3b000000, v192
    v_mul_f32 v194, 0x3b000000, v194
    v_fma_f32 v194, -v192, v192, v194
    v_max_f32 v194, 0, v194
    v_cvt_pk_bf16_f32 v193, v192, v194
    v_and_b32 v194, s76, v193
    v_add_f32 v194, 0x3727c5ac, v194
    v_cvt_pk_bf16_f32 v194, v194, v194
    v_and_b32 v194, s76, v194
    v_sqrt_f32 v194, v194
    v_lshlrev_b32 v192, 16, v193
    v_cvt_pk_bf16_f32 v194, v194, v194
    v_and_b32 v194, s76, v194
    v_rcp_f32 v194, v194
    v_sub_f32 v176, v176, v192
    v_sub_f32 v177, v177, v192
    v_sub_f32 v178, v178, v192
    v_sub_f32 v179, v179, v192
    v_sub_f32 v180, v180, v192
    v_sub_f32 v181, v181, v192
    v_sub_f32 v182, v182, v192
    v_sub_f32 v183, v183, v192
    v_cvt_pk_bf16_f32 v177, v176, v177
    v_cvt_pk_bf16_f32 v179, v178, v179
    v_cvt_pk_bf16_f32 v181, v180, v181
    v_cvt_pk_bf16_f32 v183, v182, v183
    v_lshlrev_b32 v176, 16, v177
    v_and_b32 v177, s76, v177
    v_lshlrev_b32 v178, 16, v179
    v_and_b32 v179, s76, v179
    v_lshlrev_b32 v180, 16, v181
    v_and_b32 v181, s76, v181
    v_lshlrev_b32 v182, 16, v183
    v_and_b32 v183, s76, v183
    v_mul_f32 v176, v176, v194
    v_mul_f32 v177, v177, v194
    v_mul_f32 v178, v178, v194
    v_mul_f32 v179, v179, v194
    v_mul_f32 v180, v180, v194
    v_mul_f32 v181, v181, v194
    v_mul_f32 v182, v182, v194
    v_mul_f32 v183, v183, v194
    v_cvt_pk_bf16_f32 v200, v176, v177
    v_cvt_pk_bf16_f32 v201, v178, v179
    v_cvt_pk_bf16_f32 v202, v180, v181
    v_cvt_pk_bf16_f32 v203, v182, v183
    ds_write_b128 v5, v[200:203] offset:2304
    s_waitcnt lgkmcnt(0)
    s_add_u32 s83, s83, 8
    s_and_b32 s73, s83, 0xf8
    v_mov_b32 v15, s73
    s_mov_b32 s77, 0xffffff00
    s_or_b32 s93, s93, s73
    v_mov_b32 v13, s93
    s_or_b32 s86, s73, 1
    v_mov_b32 v6, s86
    s_bfe_u32 s85, s83, 0x30008
    s_lshl_b32 s85, s85, 18
    s_add_u32 s85, s85, 0x200000
    s_xor_b32 s85, s85, 0x1e0000
    s_xor_b32 s79, s88, s85
L_qs:
L_qs_retry:
    ds_read_b32 v206, v14 offset:1036
    s_waitcnt lgkmcnt(0)
    v_cmp_gt_u32 vcc, s84, v206
    s_cbranch_vccz L_qs_ok
    s_sub_u32 s82, s82, 1
    s_cmp_ge_i32 s82, 0
    s_cbranch_scc1 L_qs_retry
L_qs_ok:
    ds_read_b64 v[204:205], v14 offset:1224
    ds_read_b128 v[16:19], v7 offset:2304
    ds_read_b64_tr_b16 v[80:81], v8
    ds_read_b64_tr_b16 v[82:83], v8 offset:512
    ds_read_b64_tr_b16 v[84:85], v9
    ds_read_b64_tr_b16 v[86:87], v9 offset:512
    ds_read_b64_tr_b16 v[88:89], v10
    ds_read_b64_tr_b16 v[90:91], v10 offset:512
    ds_read_b64_tr_b16 v[92:93], v11
    ds_read_b64_tr_b16 v[94:95], v11 offset:512
    v_add_u32 v7, 64, v7
    v_add_u32 v8, 0x1000, v8
    v_add_u32 v9, 0x1000, v9
    v_add_u32 v10, 0x1000, v10
    v_add_u32 v11, 0x1000, v11
    s_add_u32 s84, s84, 4
    s_cmp_le_u32 s84, 32
    s_waitcnt lgkmcnt(6)
    v_mfma_f32_16x16x32_bf16 v[208:211], v[80:83], v[16:19], v[208:211]
    s_waitcnt lgkmcnt(4)
    v_mfma_f32_16x16x32_bf16 v[212:215], v[84:87], v[16:19], v[212:215]
    s_waitcnt lgkmcnt(2)
    v_mfma_f32_16x16x32_bf16 v[216:219], v[88:91], v[16:19], v[216:219]
    s_waitcnt lgkmcnt(0)
    v_mfma_f32_16x16x32_bf16 v[220:223], v[92:95], v[16:19], v[220:223]
    s_cbranch_scc1 L_qs
    v_sub_u32 v3, v205, v204
    v_mul_u32_u24 v4, v205, v204
    v_cmp_ne_u32 vcc, 0, v4
    s_nop 1
    v_cndmask_b32 v3, 0, v3, vcc
    v_cmp_lt_i32 vcc, 40, v3
    s_nop 1
    v_addc_co_u32 v4, vcc, 1, v15, vcc
    v_cmp_gt_i32 vcc, -40, v3
    s_nop 1
    v_subbrev_co_u32 v4, vcc, 0, v4, vcc
    s_mov_b32 exec_lo, 0x30003
    s_mov_b32 exec_hi, 0x30003
    v_and_or_b32 v208, v208, s77, v13
    v_and_or_b32 v209, v209, s77, v4
    v_and_or_b32 v210, v210, s77, v15
    v_and_or_b32 v211, v211, s77, v6
    buffer_store_dwordx4 v[208:211], v12, s[60:63], s88 offen offset:0
    v_and_or_b32 v212, v212, s77, v13
    v_and_or_b32 v213, v213, s77, v4
    v_and_or_b32 v214, v214, s77, v15
    v_and_or_b32 v215, v215, s77, v6
    buffer_store_dwordx4 v[212:215], v12, s[60:63], s88 offen offset:64
    v_and_or_b32 v216, v216, s77, v13
    v_and_or_b32 v217, v217, s77, v4
    v_and_or_b32 v218, v218, s77, v15
    v_and_or_b32 v219, v219, s77, v6
    buffer_store_dwordx4 v[216:219], v12, s[60:63], s88 offen offset:128
    v_and_or_b32 v220, v220, s77, v13
    v_and_or_b32 v221, v221, s77, v4
    v_and_or_b32 v222, v222, s77, v15
    v_and_or_b32 v223, v223, s77, v6
    buffer_store_dwordx4 v[220:223], v12, s[60:63], s88 offen offset:192
    s_mov_b64 exec, -1
    v_bfe_u32 v9, v1, 3, 3
    v_lshlrev_b32 v9, 8, v9
    v_bfe_u32 v2, v1, 0, 3
    v_lshl_or_b32 v9, v2, 4, v9
    v_bfe_u32 v10, v1, 3, 3
    v_lshlrev_b32 v10, 7, v10
    v_bfe_u32 v2, v1, 0, 3
    v_lshl_or_b32 v10, v2, 3, v10
    s_mov_b32 s91, 64
    s_mov_b64 s[40:41], -1
L_qw_retry:
    ds_read_b32 v206, v14 offset:1036
    s_waitcnt lgkmcnt(0)
    v_cmp_gt_u32 vcc, s91, v206
    s_cbranch_vccz L_qw_ok
    s_sleep 4
    s_sub_u32 s82, s82, 1
    s_cmp_ge_i32 s82, 0
    s_cbranch_scc1 L_qw_retry
L_qw_ok:
    s_memrealtime s[96:97]
    s_mov_b64 exec, s[40:41]
    buffer_load_dwordx4 v[16:19], v9, s[60:63], s81 offen sc1
    buffer_load_dwordx4 v[20:23], v9, s[60:63], s81 offen offset:128 sc1
    buffer_load_dwordx4 v[24:27], v9, s[60:63], s81 offen offset:2048 sc1
    buffer_load_dwordx4 v[28:31], v9, s[60:63], s81 offen offset:2176 sc1
    buffer_load_dwordx4 v[32:35], v9, s[60:63], s80 offen sc1
    buffer_load_dwordx4 v[36:39], v9, s[60:63], s80 offen offset:128 sc1
    buffer_load_dwordx4 v[40:43], v9, s[60:63], s80 offen offset:2048 sc1
    buffer_load_dwordx4 v[44:47], v9, s[60:63], s80 offen offset:2176 sc1
    s_mov_b64 exec, -1
    s_waitcnt lgkmcnt(0)
    s_sub_u32 s96, s96, s3
    s_cmp_ge_u32 s96, 285
    s_cbranch_scc1 L_q_one
    s_sleep 8
L_q_loop:
    s_mov_b64 exec, s[40:41]
    buffer_load_dwordx4 v[16:19], v9, s[60:63], s81 offen sc1
    buffer_load_dwordx4 v[20:23], v9, s[60:63], s81 offen offset:128 sc1
    buffer_load_dwordx4 v[24:27], v9, s[60:63], s81 offen offset:2048 sc1
    buffer_load_dwordx4 v[28:31], v9, s[60:63], s81 offen offset:2176 sc1
    buffer_load_dwordx4 v[32:35], v9, s[60:63], s80 offen sc1
    buffer_load_dwordx4 v[36:39], v9, s[60:63], s80 offen offset:128 sc1
    buffer_load_dwordx4 v[40:43], v9, s[60:63], s80 offen offset:2048 sc1
    buffer_load_dwordx4 v[44:47], v9, s[60:63], s80 offen offset:2176 sc1
    s_mov_b64 exec, -1
    s_cmp_gt_i32 s89, 0
    s_cbranch_scc1 L_q_fw
L_q_one:
    s_waitcnt vmcnt(0)
L_q_fw:
    s_waitcnt vmcnt(8)
    v_bitop3_b32 v176, v16, v20, s93 bitop3:0x7e
    v_bitop3_b32 v177, v24, v28, s93 bitop3:0x7e
    v_bitop3_b32 v178, v32, v36, s93 bitop3:0x7e
    v_bitop3_b32 v179, v40, v44, s93 bitop3:0x7e
    v_or3_b32 v176, v176, v177, v178
    v_or_b32 v179, v179, v176
    v_bitop3_b32 v180, v17, v21, s73 bitop3:0x7e
    v_bitop3_b32 v181, v25, v29, s73 bitop3:0x7e
    v_bitop3_b32 v182, v33, v37, s73 bitop3:0x7e
    v_bitop3_b32 v183, v41, v45, s73 bitop3:0x7e
    v_or3_b32 v180, v180, v181, v182
    v_or_b32 v183, v183, v180
    v_bitop3_b32 v188, v18, v22, s73 bitop3:0x7e
    v_bitop3_b32 v189, v26, v30, s73 bitop3:0x7e
    v_bitop3_b32 v190, v34, v38, s73 bitop3:0x7e
    v_bitop3_b32 v191, v42, v46, s73 bitop3:0x7e
    v_or3_b32 v188, v188, v189, v190
    v_or_b32 v191, v191, v188
    v_bitop3_b32 v192, v19, v23, s86 bitop3:0x7e
    v_bitop3_b32 v193, v27, v31, s86 bitop3:0x7e
    v_bitop3_b32 v194, v35, v39, s86 bitop3:0x7e
    v_bitop3_b32 v195, v43, v47, s86 bitop3:0x7e
    v_or3_b32 v192, v192, v193, v194
    v_or_b32 v195, v195, v192
    v_or_b32 v191, v191, v195
    v_or_b32 v184, v179, v183
    v_and_b32 v184, 0xf8, v184
    v_and_or_b32 v184, v191, s90, v184
    s_nop 1
    v_or_b32_dpp v184, v184, v184 quad_perm:[1,0,3,2] row_mask:0xf bank_mask:0xf
    s_nop 1
    v_or_b32_dpp v184, v184, v184 quad_perm:[2,3,0,1] row_mask:0xf bank_mask:0xf
    s_nop 1
    v_or_b32_dpp v184, v184, v184 row_half_mirror row_mask:0xf bank_mask:0xf
    v_cmp_ne_u32 s[40:41], 0, v184
    s_cmp_eq_u64 s[40:41], 0
    s_cbranch_scc1 L_q_ok
    s_sub_u32 s82, s82, 1
    s_cmp_lt_i32 s82, 0
    s_cbranch_scc1 L_q_ok
    s_sub_u32 s89, s89, 1
    s_cmp_gt_i32 s89, 0
    s_cbranch_scc1 L_q_loop
    s_cmp_lg_u32 s89, 0
    s_cbranch_scc1 L_q_alt
    s_mov_b32 exec_lo, 0x30003
    s_mov_b32 exec_hi, 0x30003
    buffer_store_dwordx4 v[208:211], v12, s[60:63], s79 offen offset:0 sc1
    buffer_store_dwordx4 v[212:215], v12, s[60:63], s79 offen offset:64 sc1
    buffer_store_dwordx4 v[216:219], v12, s[60:63], s79 offen offset:128 sc1
    buffer_store_dwordx4 v[220:223], v12, s[60:63], s79 offen offset:192 sc1
    s_mov_b64 exec, -1
L_q_alt:
    s_xor_b32 s81, s81, s85
    s_xor_b32 s80, s80, s85
    s_branch L_q_loop
L_q_ok:
    v_pk_add_f32 v[188:189], v[16:17], v[24:25]
    v_pk_add_f32 v[190:191], v[18:19], v[26:27]
    v_pk_add_f32 v[192:193], v[20:21], v[28:29]
    v_pk_add_f32 v[194:195], v[22:23], v[30:31]
    v_pk_add_f32 v[200:201], v[32:33], v[40:41]
    v_pk_add_f32 v[202:203], v[34:35], v[42:43]
    v_pk_add_f32 v[204:205], v[36:37], v[44:45]
    v_pk_add_f32 v[206:207], v[38:39], v[46:47]
    v_pk_add_f32 v[188:189], v[188:189], v[200:201]
    v_pk_add_f32 v[190:191], v[190:191], v[202:203]
    v_pk_add_f32 v[192:193], v[192:193], v[204:205]
    v_pk_add_f32 v[194:195], v[194:195], v[206:207]
    v_cvt_pk_bf16_f32 v196, v188, v189
    v_cvt_pk_bf16_f32 v197, v190, v191
    v_cvt_pk_bf16_f32 v198, v192, v193
    v_cvt_pk_bf16_f32 v199, v194, v195
    ds_write_b64 v10, v[196:197] offset:2304
    ds_write_b64 v10, v[198:199] offset:2368
    v_bitop3_b32 v176, v16, v20, s93 bitop3:0x7e
    v_bitop3_b32 v177, v24, v28, s93 bitop3:0x7e
    v_bitop3_b32 v178, v32, v36, s93 bitop3:0x7e
    v_bitop3_b32 v179, v40, v44, s93 bitop3:0x7e
    v_or3_b32 v176, v176, v177, v178
    v_or_b32 v179, v179, v176
    v_and_b32 v184, 7, v179
    v_cmp_ne_u32 vcc, 0, v184
    s_mov_b32 s78, 2
    s_cbranch_vccz L_q_loc
    s_mov_b32 s78, 1
    s_mov_b32 exec_lo, 0x30003
    s_mov_b32 exec_hi, 0x30003
    buffer_store_dwordx4 v[208:211], v12, s[60:63], s79 offen offset:0 sc1
    buffer_store_dwordx4 v[212:215], v12, s[60:63], s79 offen offset:64 sc1
    buffer_store_dwordx4 v[216:219], v12, s[60:63], s79 offen offset:128 sc1
    buffer_store_dwordx4 v[220:223], v12, s[60:63], s79 offen offset:192 sc1
    s_mov_b64 exec, -1
L_q_loc:
    v_mov_b32 v184, s78
    ds_write_b32 v14, v184 offset:1024
    s_and_b32 s73, s83, 0x3f8
    v_mov_b32 v15, s73
    s_mov_b32 s77, 0xfffffc00
    v_and_b32 v184, 3, v17
    v_and_b32 v185, 3, v25
    v_and_b32 v186, 3, v33
    v_and_b32 v187, 3, v41
    v_add3_u32 v184, v184, v185, v186
    v_add_u32 v184, v184, v187
    s_nop 1
    v_add_u32_dpp v184, v184, v184 row_ror:8 row_mask:0xf bank_mask:0xf
    v_mov_b32 v185, v184
    s_nop 1
    v_permlane16_swap_b32 v184, v185
    v_add_u32 v184, v184, v185
    v_mov_b32 v185, v184
    s_nop 1
    v_permlane32_swap_b32 v184, v185
    v_add_u32 v184, v184, v185
    s_nop 0
    v_readfirstlane_b32 s78, v184
    s_cmp_ge_u32 s78, 32
    s_cselect_b32 s78, 1, 2
    v_mov_b32 v184, s78
    v_mov_b32 v185, s83
    ds_write_b64 v14, v[184:185] offset:1232
    s_branch L_role_common
L_other:
    v_mov_b32 v14, 0
    s_mov_b32 s76, 0xffff0000
    s_mov_b32 s77, 0xfffffc00
    s_mov_b32 s82, 5000000
    s_cmp_ge_u32 s68, 4
    s_cbranch_scc1 L_kv
    v_lshlrev_b32 v6, 7, v1
    s_lshl_b32 s78, s69, 16
    s_bfe_u32 s97, s70, 0x40000
    s_lshl_b32 s97, s97, 12
    s_add_u32 s78, s78, s97
    s_add_u32 s78, s78, 0x20000
    s_cmp_ge_u32 s70, 16
    s_cselect_b32 s80, -1, 1
    s_and_b32 s79, s70, 0x13
    s_cmp_eq_u32 s79, 0x13
    s_cselect_b32 s80, 1, s80
    s_cmp_eq_u32 s79, 0x12
    s_cselect_b32 s81, -1, 0
    s_cmp_eq_u32 s68, 2
    s_cbranch_scc1 L_pre_go
    v_bfe_u32 v6, v1, 0, 1
    v_lshlrev_b32 v6, 7, v6
    v_bfe_u32 v2, v1, 1, 1
    v_lshl_or_b32 v6, v2, 13, v6
    s_lshl_b32 s78, s69, 14
    s_lshr_b32 s97, s70, 3
    s_lshl_b32 s97, s97, 11
    s_add_u32 s78, s78, s97
    s_bfe_u32 s97, s70, 0x30000
    s_lshl_b32 s97, s97, 8
    s_add_u32 s78, s78, s97
    s_add_u32 s78, s78, 0x1e0000
    s_lshl_b32 s79, s69, 12
    s_lshl_b32 s97, s70, 7
    s_add_u32 s79, s79, s97
    s_add_u32 s79, s79, 0x18000
    s_sub_u32 s79, s79, s78
    v_writelane_b32 v6, s79, 4
    v_add_u32 v6, s78, v6
    s_mov_b32 s78, 0
    s_mov_b32 s80, 0xf
    s_mov_b32 s81, 0
L_pre_go:
    s_waitcnt lgkmcnt(0)
    s_mov_b32 s3, s98
    s_load_dword s83, s[26:27], 0
    s_mov_b32 s60, s26
    s_and_b32 s61, s27, 0xffff
    s_mov_b32 s62, 0x1000000
    s_mov_b32 s63, 0x20000
    s_mov_b32 exec_hi, s81
    s_mov_b32 exec_lo, s80
    buffer_load_dword v7, v6, s[60:63], s78 offen nt
    s_mov_b64 exec, -1
L_pt_a:
    s_mov_b32 s28, s4
    s_and_b32 s29, s5, 0xffff
    s_mov_b32 s30, 0x800
    s_mov_b32 s31, 0x20000
    s_mov_b32 s44, s12
    s_and_b32 s45, s13, 0xffff
    s_mov_b32 s46, 0x400000
    s_mov_b32 s47, 0x20000
    s_mov_b32 s48, s16
    s_and_b32 s49, s17, 0xffff
    s_mov_b32 s50, 0x1c0000
    s_mov_b32 s51, 0x20000
    s_mov_b32 s52, s18
    s_and_b32 s53, s19, 0xffff
    s_mov_b32 s54, 0x1c0000
    s_mov_b32 s55, 0x20000
    s_mov_b32 s56, s20
    s_and_b32 s57, s21, 0xffff
    s_mov_b32 s58, 0x1c0000
    s_mov_b32 s59, 0x20000
    s_mov_b32 s64, s22
    s_and_b32 s65, s23, 0xffff
    s_mov_b32 s66, 0x800
    s_mov_b32 s67, 0x20000
    s_waitcnt vmcnt(0) lgkmcnt(0)
    s_mov_b32 exec_hi, s81
    s_mov_b32 exec_lo, s80
    buffer_load_dword v7, v6, s[60:63], s78 offen sc1
    s_mov_b64 exec, -1
L_pt_c:
    s_add_u32 s83, s83, 8
    s_and_b32 s73, s83, 0x3f8
    v_mov_b32 v15, s73
    s_waitcnt vmcnt(0)
L_role_common:
    s_nop 3
    s_mov_b32 s74, 0x05040100
    s_mov_b32 s75, 0x07060302
    s_cmp_ge_u32 s70, 16
    s_cbranch_scc1 L_ffn
    v_bfe_u32 v10, v1, 4, 2
    v_lshlrev_b32 v10, 11, v10
    v_bfe_u32 v2, v1, 0, 4
    v_lshl_or_b32 v10, v2, 4, v10
    s_lshl_b32 s88, s69, 19
    s_lshr_b32 s97, s70, 2
    s_lshl_b32 s97, s97, 17
    s_add_u32 s88, s88, s97
    s_bfe_u32 s97, s70, 0x10000
    s_lshl_b32 s97, s97, 16
    s_add_u32 s88, s88, s97
    s_bfe_u32 s97, s70, 0x10001
    s_lshl_b32 s97, s97, 13
    s_add_u32 s88, s88, s97
    s_lshl_b32 s97, s68, 8
    s_add_u32 s88, s88, s97
    s_add_u32 s89, s88, 16384
    s_add_u32 s90, s88, 32768
    s_add_u32 s91, s88, 49152
    v_and_b32 v6, 16, v1
    v_cmp_ne_u32 s[94:95], 0, v6
    v_bfe_u32 v12, v1, 5, 1
    v_lshlrev_b32 v12, 11, v12
    v_bfe_u32 v2, v1, 3, 2
    v_lshl_or_b32 v12, v2, 7, v12
    v_bfe_u32 v2, v1, 0, 3
    v_lshl_or_b32 v12, v2, 4, v12
    v_bfe_u32 v4, v1, 3, 3
    v_lshlrev_b32 v4, 12, v4
    v_bfe_u32 v2, v1, 0, 3
    v_lshl_or_b32 v4, v2, 4, v4
    s_or_b32 s93, s73, 4
    v_mov_b32 v7, s93
    v_bfe_u32 v8, v1, 2, 4
    v_lshlrev_b32 v8, 7, v8
    v_bfe_u32 v6, v1, 2, 4
    v_lshlrev_b32 v6, 7, v6
    v_bfe_u32 v2, v1, 0, 2
    v_lshl_or_b32 v6, v2, 4, v6
    s_lshl_b32 s85, s69, 12
    s_bfe_u32 s97, s68, 0x10001
    s_lshl_b32 s97, s97, 11
    s_add_u32 s85, s85, s97
    s_lshr_b32 s97, s70, 2
    s_lshl_b32 s97, s97, 4
    s_add_u32 s85, s85, s97
    s_add_u32 s85, s85, 0x18000
    s_lshl_b32 s78, s69, 16
    s_lshl_b32 s97, s70, 12
    s_add_u32 s78, s78, s97
    s_bfe_u32 s97, s68, 0x10001
    s_lshl_b32 s97, s97, 11
    s_add_u32 s78, s78, s97
    s_bfe_u32 s97, s68, 0x10000
    s_lshl_b32 s97, s97, 6
    s_add_u32 s78, s78, s97
    s_add_u32 s78, s78, 0x20000
    s_lshl_b32 s80, s69, 16
    s_lshl_b32 s97, s70, 12
    s_add_u32 s80, s80, s97
    s_lshl_b32 s97, s68, 9
    s_add_u32 s80, s80, s97
    s_add_u32 s80, s80, 0x20000
    s_lshl_b32 s79, s69, 16
    s_lshl_b32 s97, s70, 8
    s_add_u32 s79, s79, s97
    s_lshl_b32 s97, s68, 7
    s_add_u32 s79, s79, s97
    s_add_u32 s79, s79, 0x20000
    s_add_u32 s87, s79, 0x8000
    s_lshr_b32 s84, s70, 2
    s_lshl_b32 s84, s84, 14
    s_bfe_u32 s97, s70, 0x20000
    s_lshl_b32 s97, s97, 11
    s_add_u32 s84, s84, s97
    s_lshl_b32 s97, s68, 10
    s_add_u32 s84, s84, s97
    s_lshl_b32 s97, s69, 7
    s_add_u32 s84, s84, s97
    s_add_u32 s84, s84, 0x120000
    v_bfe_u32 v13, v1, 4, 2
    v_lshlrev_b32 v13, 5, v13
    v_bfe_u32 v2, v1, 0, 3
    v_lshl_or_b32 v13, v2, 2, v13
    v_bfe_u32 v2, v1, 3, 1
    v_lshl_or_b32 v13, v2, 13, v13
    s_lshl_b32 s81, s68, 5
    v_bfe_u32 v11, v1, 0, 2
    v_lshlrev_b32 v11, 3, v11
    v_bfe_u32 v2, v1, 4, 1
    v_lshl_or_b32 v11, v2, 2, v11
    v_bfe_u32 v2, v1, 5, 1
    v_lshl_or_b32 v11, v2, 1, v11
    v_add_u32 v11, s81, v11
    v_bfe_u32 v9, v1, 3, 1
    v_lshlrev_b32 v9, 6, v9
    v_bfe_u32 v2, v1, 4, 2
    v_lshl_or_b32 v9, v2, 4, v9
L_vi_retry:
    ds_read_b32 v176, v14 offset:1032
    s_waitcnt lgkmcnt(0)
    v_cmp_eq_u32 vcc, 0, v176
    s_cbranch_vccz L_vi_ok
    s_sleep 2
    s_sub_u32 s82, s82, 1
    s_cmp_ge_i32 s82, 0
    s_cbranch_scc1 L_vi_retry
L_vi_ok:
    buffer_load_dwordx4 v[144:147], v10, s[44:47], s88 offen offset:0 nt
    buffer_load_dwordx4 v[148:151], v10, s[44:47], s89 offen offset:0 nt
    buffer_load_dwordx4 v[152:155], v10, s[44:47], s90 offen offset:0 nt
    buffer_load_dwordx4 v[156:159], v10, s[44:47], s91 offen offset:0 nt
    v_cmp_eq_u32 vcc, 2, v176
    s_cbranch_vccnz L_wot_ok
    s_memrealtime s[96:97]
    s_waitcnt lgkmcnt(0)
    s_sub_u32 s81, s96, s3
    s_cmp_ge_u32 s81, 597
    s_cbranch_scc1 L_wot_ok
    s_sub_u32 s96, 597, s81
    s_mul_i32 s96, s96, 6
    s_lshr_b32 s96, s96, 3
    s_min_u32 s96, s96, 75
    s_add_u32 s81, s81, s96
L_wot_retry:
    s_memrealtime s[96:97]
    s_waitcnt lgkmcnt(0)
    s_sub_u32 s96, s96, s3
    s_cmp_ge_u32 s96, s81
    s_cbranch_scc1 L_wot_ok
    s_sleep 1
    s_sub_u32 s82, s82, 1
    s_cmp_ge_i32 s82, 0
    s_cbranch_scc1 L_wot_retry
L_wot_ok:
    buffer_load_dwordx4 v[96:99], v8, s[60:63], s85 offen sc1
    buffer_load_dwordx4 v[160:163], v10, s[44:47], s88 offen offset:1024 nt
    buffer_load_dwordx4 v[164:167], v10, s[44:47], s89 offen offset:1024 nt
    buffer_load_dwordx4 v[168:171], v10, s[44:47], s90 offen offset:1024 nt
    buffer_load_dwordx4 v[172:175], v10, s[44:47], s91 offen offset:1024 nt
L_wq_retry:
    ds_read_b32 v176, v14 offset:1024
    s_waitcnt lgkmcnt(0)
    v_cmp_eq_u32 vcc, 0, v176
    s_cbranch_vccz L_wq_ok
    s_sleep 2
    s_sub_u32 s82, s82, 1
    s_cmp_ge_i32 s82, 0
    s_cbranch_scc1 L_wq_retry
L_wq_ok:
    v_readfirstlane_b32 s92, v176
    s_add_u32 s89, s84, 0x10000
    s_add_u32 s90, s84, 0x20000
    s_add_u32 s91, s84, 0x30000
    s_waitcnt vmcnt(4)
    v_bitop3_b32 v176, v98, v99, s83 bitop3:0x7e
    v_cmp_ne_u32 vcc, 0, v176
    s_cbranch_vccnz L_ml_late
    v_max_f32_dpp v176, v96, v96 row_ror:4 row_mask:0xf bank_mask:0xf
    v_perm_b32 v16, v148, v144, s74
    v_perm_b32 v20, v148, v144, s75
    v_max_f32_dpp v176, v176, v176 row_ror:8 row_mask:0xf bank_mask:0xf
    v_perm_b32 v24, v149, v145, s74
    v_mov_b32 v177, v176
    v_perm_b32 v28, v149, v145, s75
    v_perm_b32 v32, v150, v146, s74
    v_permlane16_swap_b32 v176, v177
    v_perm_b32 v36, v150, v146, s75
    v_max_f32 v176, v176, v177
    v_perm_b32 v40, v151, v147, s74
    v_mov_b32 v177, v176
    v_perm_b32 v44, v151, v147, s75
    v_perm_b32 v17, v156, v152, s74
    v_permlane32_swap_b32 v176, v177
    v_perm_b32 v21, v156, v152, s75
    v_max_f32 v176, v176, v177
    v_perm_b32 v25, v157, v153, s74
    v_sub_f32 v96, v96, v176
    v_perm_b32 v29, v157, v153, s75
    v_mul_f32 v96, 0x3fb8aa3b, v96
    v_perm_b32 v33, v158, v154, s74
    v_exp_f32 v96, v96
    v_perm_b32 v37, v158, v154, s75
    v_mul_f32 v97, v97, v96
    v_perm_b32 v41, v159, v155, s74
    v_perm_b32 v45, v159, v155, s75
    v_add_f32_dpp v97, v97, v97 row_ror:4 row_mask:0xf bank_mask:0xf
    s_nop 1
    v_add_f32_dpp v97, v97, v97 row_ror:8 row_mask:0xf bank_mask:0xf
    v_mov_b32 v177, v97
    s_nop 1
    v_permlane16_swap_b32 v97, v177
    v_add_f32 v97, v97, v177
    v_mov_b32 v177, v97
    s_nop 1
    v_permlane32_swap_b32 v97, v177
    v_add_f32 v97, v97, v177
    v_rcp_f32 v97, v97
    s_nop 0
    v_mul_f32 v96, v96, v97
    s_waitcnt vmcnt(2)
    buffer_load_dwordx4 v[112:115], v6, s[60:63], s78 offen sc1
    v_perm_b32 v18, v164, v160, s74
    v_perm_b32 v22, v164, v160, s75
    v_perm_b32 v26, v165, v161, s74
    v_perm_b32 v30, v165, v161, s75
    v_perm_b32 v34, v166, v162, s74
    v_perm_b32 v38, v166, v162, s75
    v_perm_b32 v42, v167, v163, s74
    v_perm_b32 v46, v167, v163, s75
    s_waitcnt vmcnt(1)
    s_branch L_o_go
L_ml_late:
    s_waitcnt vmcnt(4)
    buffer_load_dwordx4 v[96:99], v8, s[60:63], s85 offen sc1
    buffer_load_dwordx4 v[112:115], v6, s[60:63], s78 offen sc1
    v_perm_b32 v16, v148, v144, s74
    v_perm_b32 v20, v148, v144, s75
    v_perm_b32 v24, v149, v145, s74
    v_perm_b32 v28, v149, v145, s75
    v_perm_b32 v32, v150, v146, s74
    v_perm_b32 v36, v150, v146, s75
    v_perm_b32 v40, v151, v147, s74
    v_perm_b32 v44, v151, v147, s75
    v_perm_b32 v17, v156, v152, s74
    v_perm_b32 v21, v156, v152, s75
    v_perm_b32 v25, v157, v153, s74
    v_perm_b32 v29, v157, v153, s75
    v_perm_b32 v33, v158, v154, s74
    v_perm_b32 v37, v158, v154, s75
    v_perm_b32 v41, v159, v155, s74
    v_perm_b32 v45, v159, v155, s75
    s_branch L_ml_chk
L_ml_retry:
    buffer_load_dwordx4 v[96:99], v8, s[60:63], s85 offen sc1
L_ml_chk:
    s_waitcnt vmcnt(0)
    v_bitop3_b32 v176, v98, v99, s83 bitop3:0x7e
    v_cmp_ne_u32 vcc, 0, v176
    s_cbranch_vccz L_ml_ok
    s_sub_u32 s82, s82, 1
    s_cmp_ge_i32 s82, 0
    s_cbranch_scc1 L_ml_retry
L_ml_ok:
    buffer_load_dwordx4 v[112:115], v6, s[60:63], s78 offen sc1
    v_max_f32_dpp v176, v96, v96 row_ror:4 row_mask:0xf bank_mask:0xf
    v_perm_b32 v18, v164, v160, s74
    v_perm_b32 v22, v164, v160, s75
    v_max_f32_dpp v176, v176, v176 row_ror:8 row_mask:0xf bank_mask:0xf
    v_perm_b32 v26, v165, v161, s74
    v_mov_b32 v177, v176
    v_perm_b32 v30, v165, v161, s75
    v_perm_b32 v34, v166, v162, s74
    v_permlane16_swap_b32 v176, v177
    v_perm_b32 v38, v166, v162, s75
    v_max_f32 v176, v176, v177
    v_perm_b32 v42, v167, v163, s74
    v_mov_b32 v177, v176
    v_perm_b32 v46, v167, v163, s75
    s_nop 0
    v_permlane32_swap_b32 v176, v177
    v_max_f32 v176, v176, v177
    v_sub_f32 v96, v96, v176
    v_mul_f32 v96, 0x3fb8aa3b, v96
    v_exp_f32 v96, v96
    s_nop 0
    v_mul_f32 v97, v97, v96
    s_nop 1
    v_add_f32_dpp v97, v97, v97 row_ror:4 row_mask:0xf bank_mask:0xf
    s_nop 1
    v_add_f32_dpp v97, v97, v97 row_ror:8 row_mask:0xf bank_mask:0xf
    v_mov_b32 v177, v97
    s_nop 1
    v_permlane16_swap_b32 v97, v177
    v_add_f32 v97, v97, v177
    v_mov_b32 v177, v97
    s_nop 1
    v_permlane32_swap_b32 v97, v177
    v_add_f32 v97, v97, v177
    v_rcp_f32 v97, v97
    s_nop 0
    v_mul_f32 v96, v96, v97
    s_branch L_o_chk
L_o_go:
    s_mov_b64 vcc, -1
L_o_retry:
    s_mov_b64 exec, vcc
    buffer_load_dwordx4 v[112:115], v6, s[60:63], s78 offen sc1
    s_mov_b64 exec, -1
    s_sub_u32 s82, s82, 1
    s_cmp_lt_i32 s82, 0
    s_cbranch_scc1 L_o_ok
    s_waitcnt vmcnt(1)
L_o_chk:
    v_bitop3_b32 v176, v113, v114, s73 bitop3:0x7e
    v_bitop3_b32 v177, v112, v115, s73 bitop3:0x7e
    v_mul_f32 v80, v112, v96
    v_mul_f32 v81, v113, v96
    v_mul_f32 v82, v114, v96
    v_mul_f32 v83, v115, v96
    v_permlane32_swap_b32 v80, v81
    v_bitop3_b32 v176, v176, v177, s77 bitop3:0x54
    v_permlane32_swap_b32 v82, v83
    v_add_f32 v80, v80, v81
    v_add_f32 v82, v82, v83
    v_cmp_ne_u32 vcc, 0, v176
    s_nop 0
    v_permlane16_swap_b32 v80, v82
    v_add_f32 v80, v80, v82
    s_cbranch_vccnz L_o_retry
L_o_ok:
    s_nop 0
    v_add_f32_dpp v80, v80, v80 row_ror:8 row_mask:0xf bank_mask:0xf
    s_nop 1
    v_add_f32_dpp v80, v80, v80 row_ror:4 row_mask:0xf bank_mask:0xf
    v_cvt_pk_bf16_f32 v80, v80, v80
    ds_write_b16 v11, v80 offset:1792
    v_perm_b32 v19, v172, v168, s74
    v_perm_b32 v23, v172, v168, s75
    v_perm_b32 v27, v173, v169, s74
    v_perm_b32 v31, v173, v169, s75
    v_perm_b32 v35, v174, v170, s74
    v_perm_b32 v39, v174, v170, s75
    v_perm_b32 v43, v175, v171, s74
    v_perm_b32 v47, v175, v171, s75
    s_waitcnt lgkmcnt(0)
    s_barrier
    ds_read_b128 v[180:183], v9 offset:1792
    s_cmp_lg_u32 s92, 2
    s_waitcnt lgkmcnt(0)
    v_mfma_f32_16x16x32_bf16 v[208:211], v[180:183], v[16:19], 0
    v_mfma_f32_16x16x32_bf16 v[224:227], v[180:183], v[32:35], 0
    v_mfma_f32_16x16x32_bf16 v[212:215], v[180:183], v[20:23], 0
    v_mfma_f32_16x16x32_bf16 v[228:231], v[180:183], v[36:39], 0
    v_mfma_f32_16x16x32_bf16 v[216:219], v[180:183], v[24:27], 0
    v_mfma_f32_16x16x32_bf16 v[232:235], v[180:183], v[40:43], 0
    v_mfma_f32_16x16x32_bf16 v[220:223], v[180:183], v[28:31], 0
    v_mfma_f32_16x16x32_bf16 v[236:239], v[180:183], v[44:47], 0
    s_nop 1
    v_cndmask_b32 v184, v208, v224, s[94:95]
    v_and_or_b32 v184, v184, s77, v7
    v_cndmask_b32 v185, v212, v228, s[94:95]
    v_and_or_b32 v185, v185, s77, v7
    v_cndmask_b32 v186, v216, v232, s[94:95]
    v_and_or_b32 v186, v186, s77, v7
    v_cndmask_b32 v187, v220, v236, s[94:95]
    v_and_or_b32 v187, v187, s77, v7
    s_cbranch_scc1 L_ls2
    buffer_store_dwordx4 v[184:187], v12, s[60:63], s80 offen
L_le2:
    s_cmp_ge_u32 s68, 2
    s_cbranch_scc1 L_w_dn
    buffer_load_dwordx4 v[120:123], v4, s[60:63], s79 offen sc1
    buffer_load_dwordx4 v[124:127], v4, s[60:63], s87 offen sc1
    s_sleep 2
    buffer_load_dwordx4 v[120:123], v4, s[60:63], s79 offen sc1
    buffer_load_dwordx4 v[124:127], v4, s[60:63], s87 offen sc1
    s_sleep 2
    s_mov_b64 vcc, -1
L_a3_retry:
    s_mov_b64 exec, vcc
    buffer_load_dwordx4 v[120:123], v4, s[60:63], s79 offen sc1
    buffer_load_dwordx4 v[124:127], v4, s[60:63], s87 offen sc1
    s_mov_b64 exec, -1
    s_sub_u32 s82, s82, 1
    s_cmp_lt_i32 s82, 0
    s_cbranch_scc1 L_a3_ok
    s_waitcnt vmcnt(5)
L_a3_chk:
    v_bitop3_b32 v176, v121, v122, s93 bitop3:0x7e
    v_bitop3_b32 v177, v120, v123, s93 bitop3:0x7e
    s_waitcnt vmcnt(4)
    v_bitop3_b32 v178, v125, v126, s93 bitop3:0x7e
    v_bitop3_b32 v179, v124, v127, s93 bitop3:0x7e
    v_pk_add_f32 v[80:81], v[120:121], v[124:125]
    v_pk_add_f32 v[82:83], v[122:123], v[126:127]
    v_or3_b32 v176, v176, v177, v178
    v_permlane32_swap_b32 v80, v81
    v_permlane32_swap_b32 v82, v83
    v_add_f32 v80, v80, v81
    v_add_f32 v82, v82, v83
    v_bitop3_b32 v179, v179, v176, s77 bitop3:0x54
    v_cmp_ne_u32 vcc, 0, v179
    v_permlane16_swap_b32 v80, v82
    v_add_f32 v80, v80, v82
    s_cbranch_vccnz L_a3_retry
L_a3_ok:
    s_nop 0
    v_add_f32_dpp v80, v80, v80 row_ror:8 row_mask:0xf bank_mask:0xf
    v_and_or_b32 v80, v80, s77, v15
    buffer_store_dword v80, v13, s[60:63], s84 offen sc1
L_w_dn:
    s_cmp_eq_u32 s69, 7
    s_cbranch_scc1 L_fin
    s_barrier
    s_bfe_u32 s78, s68, 0x10000
    s_lshl_b32 s78, s78, 7
    s_bfe_u32 s97, s68, 0x10001
    s_lshl_b32 s97, s97, 3
    s_add_u32 s78, s78, s97
    v_bfe_u32 v10, v1, 4, 2
    v_lshlrev_b32 v10, 11, v10
    v_bfe_u32 v2, v1, 2, 2
    v_lshl_or_b32 v10, v2, 8, v10
    v_bfe_u32 v2, v1, 0, 2
    v_lshl_or_b32 v10, v2, 4, v10
    v_add_u32 v10, s78, v10
    v_add_u32 v10, 0x3000, v10
    v_bfe_u32 v3, v1, 0, 1
    v_lshlrev_b32 v3, 7, v3
    v_bfe_u32 v2, v1, 4, 2
    v_lshl_or_b32 v3, v2, 4, v3
    v_bfe_u32 v12, v1, 0, 1
    v_lshlrev_b32 v12, 17, v12
    v_bfe_u32 v2, v1, 1, 1
    v_lshl_or_b32 v12, v2, 6, v12
    v_bfe_u32 v2, v1, 4, 2
    v_lshl_or_b32 v12, v2, 4, v12
    v_bfe_u32 v2, v1, 2, 1
    v_lshl_or_b32 v12, v2, 13, v12
    s_bfe_u32 s80, s70, 0x20000
    s_lshl_b32 s80, s80, 15
    s_bfe_u32 s97, s68, 0x10001
    s_lshl_b32 s97, s97, 14
    s_add_u32 s80, s80, s97
    s_bfe_u32 s97, s68, 0x10000
    s_lshl_b32 s97, s97, 12
    s_add_u32 s80, s80, s97
    s_lshl_b32 s97, s69, 9
    s_add_u32 s80, s80, s97
    s_lshr_b32 s97, s70, 2
    s_lshl_b32 s97, s97, 7
    s_add_u32 s80, s80, s97
    s_add_u32 s80, s80, 0xa0000
    v_and_b32 v177, 2, v1
    v_cmp_ne_u32 s[94:95], 0, v177
    s_branch L_fd_retry
    s_branch L_fin
L_ffn:
L_par_retry:
    ds_read_b128 v[176:179], v14 offset:1232
    s_waitcnt lgkmcnt(0)
    v_cmp_eq_u32 vcc, 0, v176
    s_cbranch_vccz L_par_ok
    s_sleep 8
    s_sub_u32 s82, s82, 1
    s_cmp_ge_i32 s82, 0
    s_cbranch_scc1 L_par_retry
L_par_ok:
    v_readfirstlane_b32 s72, v176
    v_readfirstlane_b32 s83, v177
    s_and_b32 s73, s83, 0x3f8
    v_mov_b32 v15, s73
    s_lshr_b32 s72, s72, 1
    s_cmp_lg_u32 s68, 2
    s_cbranch_scc1 L_nopp
    v_lshlrev_b32 v6, 7, v1
    s_bfe_u32 s81, s70, 0x20002
    s_lshl_b32 s81, s81, 14
    s_bfe_u32 s97, s70, 0x20000
    s_lshl_b32 s97, s97, 11
    s_add_u32 s81, s81, s97
    s_bfe_u32 s97, s69, 0x10003
    s_lshl_b32 s97, s97, 16
    s_add_u32 s81, s81, s97
    s_lshl_b32 s97, s72, 13
    s_add_u32 s81, s81, s97
    s_add_u32 s81, s81, 0x120000
    s_mov_b32 s79, 128
L_ppw_retry:
    ds_read_b32 v206, v14 offset:1036
    s_waitcnt lgkmcnt(0)
    v_cmp_gt_u32 vcc, s79, v206
    s_cbranch_vccz L_ppw_ok
    s_sleep 8
    s_sub_u32 s82, s82, 1
    s_cmp_ge_i32 s82, 0
    s_cbranch_scc1 L_ppw_retry
L_ppw_ok:
    s_lshl_b32 s80, s69, 14
    s_bfe_u32 s97, s70, 0x40000
    s_lshl_b32 s97, s97, 10
    s_add_u32 s80, s80, s97
    s_add_u32 s80, s80, 0x180000
    s_mov_b32 s79, 0x1000
    s_mov_b64 exec, 0xffff
    buffer_load_dword v253, v6, s[60:63], s81 offen sc1
    s_mov_b32 s71, s3
    s_mov_b64 exec, -1
L_nopp:
    s_cmp_eq_u32 s69, 7
    s_cbranch_scc1 L_rrole
    s_lshl_b32 s93, s69, 2
    s_bfe_u32 s97, s70, 0x20002
    s_add_u32 s93, s93, s97
    s_mov_b32 s91, s93
    v_lshrrev_b32 v10, 3, v1
    v_mul_u32_u24 v10, 3584, v10
    v_bfe_u32 v11, v1, 0, 3
    v_lshlrev_b32 v11, 4, v11
    v_or_b32 v10, v10, v11
    v_bfe_u32 v11, v1, 4, 1
    v_lshlrev_b32 v11, 5, v11
    v_xor_b32 v10, v10, v11
    v_xor_b32 v11, 64, v10
    v_add_u32 v11, 0x6c00, v11
    v_add_u32 v12, 0xd800, v10
    v_add_u32 v13, 0xd800, v11
    s_and_b32 s81, s70, 3
    s_mul_i32 s78, s81, 458752
    s_lshl_b32 s97, s91, 7
    s_add_u32 s78, s78, s97
    s_mov_b32 s79, 0x1c000
    v_bfe_u32 v6, v1, 2, 1
    v_lshlrev_b32 v6, 1, v6
    v_bfe_u32 v2, v1, 1, 1
    v_lshl_or_b32 v6, v2, 2, v6
    v_bfe_u32 v2, v1, 5, 1
    v_lshl_or_b32 v6, v2, 4, v6
    v_bfe_u32 v2, v1, 4, 1
    v_lshl_or_b32 v6, v2, 5, v6
    v_bfe_u32 v2, v1, 0, 1
    v_lshl_or_b32 v6, v2, 6, v6
    v_bfe_u32 v2, v1, 3, 1
    v_lshl_or_b32 v6, v2, 10, v6
    s_bfe_u32 s84, s70, 0x20000
    s_lshl_b32 s84, s84, 8
    s_bfe_u32 s97, s68, 0x10000
    s_lshl_b32 s97, s97, 7
    s_add_u32 s84, s84, s97
    s_bfe_u32 s97, s68, 0x10001
    s_lshl_b32 s97, s97, 3
    s_add_u32 s84, s84, s97
    buffer_load_ushort v252, v6, s[28:31], s84 offen
    s_lshl_b32 s80, s68, 13
    s_add_u32 s80, s80, 0x7000
    s_mov_b32 m0, s80
    s_bitcmp1_b32 s68, 0
    s_cselect_b32 s80, 0x38000, 0
    s_add_u32 s78, s78, s80
    s_add_u32 s79, s79, s78
    s_cmp_ge_u32 s68, 2
    s_cselect_b64 s[48:49], s[52:53], s[48:49]
    s_cmp_ge_u32 s70, 28
    s_cselect_b32 s86, 35, 0
    s_sub_u32 s85, 70, s86
    s_sub_u32 s86, 662, s86
L_fg_retry:
    ds_read_b32 v176, v14 offset:1028
    s_waitcnt lgkmcnt(0)
    v_cmp_eq_u32 vcc, 0, v176
    s_cbranch_vccz L_fg_ok
    s_sleep 2
    s_sub_u32 s82, s82, 1
    s_cmp_ge_i32 s82, 0
    s_cbranch_scc1 L_fg_retry
L_fg_ok:
    s_memrealtime s[96:97]
    s_waitcnt lgkmcnt(0)
    s_sub_u32 s80, s96, s3
    s_cmp_ge_u32 s80, s86
    s_cbranch_scc1 L_fft_ok
    s_add_u32 s80, s80, s85
    s_min_u32 s80, s80, s86
L_fft_retry:
    s_memrealtime s[96:97]
    s_waitcnt lgkmcnt(0)
    s_sub_u32 s96, s96, s3
    s_cmp_ge_u32 s96, s80
    s_cbranch_scc1 L_fft_ok
    s_sleep 1
    s_sub_u32 s82, s82, 1
    s_cmp_ge_i32 s82, 0
    s_cbranch_scc1 L_fft_retry
L_fft_ok:
    buffer_load_dwordx4 v10, s[48:51], s78 offen offset:0 nt lds
    buffer_load_dwordx4 v11, s[48:51], s78 offen offset:1024 nt lds
    buffer_load_dwordx4 v12, s[48:51], s78 offen offset:2048 nt lds
    buffer_load_dwordx4 v13, s[48:51], s78 offen offset:3072 nt lds
    s_add_u32 m0, m0, 4096
    s_nop 0
    buffer_load_dwordx4 v10, s[48:51], s79 offen offset:0 nt lds
    buffer_load_dwordx4 v11, s[48:51], s79 offen offset:1024 nt lds
    buffer_load_dwordx4 v12, s[48:51], s79 offen offset:2048 nt lds
    buffer_load_dwordx4 v13, s[48:51], s79 offen offset:3072 nt lds
L_f_issued:
    v_bfe_u32 v8, v1, 4, 2
    v_lshlrev_b32 v8, 10, v8
    v_bfe_u32 v2, v1, 2, 2
    v_lshl_or_b32 v8, v2, 7, v8
    v_bfe_u32 v2, v1, 4, 1
    v_lshl_or_b32 v8, v2, 6, v8
    v_bfe_u32 v2, v1, 3, 1
    v_lshl_or_b32 v8, v2, 5, v8
    v_bfe_u32 v2, v1, 1, 1
    v_lshl_or_b32 v8, v2, 4, v8
    v_bfe_u32 v2, v1, 0, 1
    v_lshl_or_b32 v8, v2, 3, v8
    s_lshl_b32 s78, s68, 5
    v_xor_b32 v8, s78, v8
    s_bfe_u32 s78, s68, 0x10000
    s_lshl_b32 s78, s78, 7
    s_bfe_u32 s97, s68, 0x10001
    s_lshl_b32 s97, s97, 3
    s_add_u32 s78, s78, s97
    v_bfe_u32 v6, v1, 2, 1
    v_lshlrev_b32 v6, 1, v6
    v_bfe_u32 v2, v1, 1, 1
    v_lshl_or_b32 v6, v2, 2, v6
    v_bfe_u32 v2, v1, 5, 1
    v_lshl_or_b32 v6, v2, 4, v6
    v_bfe_u32 v2, v1, 4, 1
    v_lshl_or_b32 v6, v2, 5, v6
    v_bfe_u32 v2, v1, 0, 1
    v_lshl_or_b32 v6, v2, 6, v6
    v_bfe_u32 v2, v1, 3, 1
    v_lshl_or_b32 v6, v2, 8, v6
    v_add_u32 v6, s78, v6
    v_bfe_u32 v7, v1, 0, 1
    v_lshlrev_b32 v7, 8, v7
    v_bfe_u32 v2, v1, 4, 2
    v_lshl_or_b32 v7, v2, 4, v7
    s_bfe_u32 s84, s70, 0x10001
    s_lshl_b32 s84, s84, 14
    s_bfe_u32 s97, s70, 0x10000
    s_lshl_b32 s97, s97, 12
    s_add_u32 s84, s84, s97
    s_lshl_b32 s97, s68, 10
    s_add_u32 s84, s84, s97
    s_bfe_u32 s97, s69, 0x10003
    s_lshl_b32 s97, s97, 16
    s_add_u32 s84, s84, s97
    s_lshl_b32 s97, s72, 13
    s_add_u32 s84, s84, s97
    s_add_u32 s84, s84, 0x120000
    s_add_u32 s85, s84, 32768
    v_bfe_u32 v11, v1, 1, 1
    v_lshlrev_b32 v11, 7, v11
    v_bfe_u32 v2, v1, 0, 1
    v_lshl_or_b32 v11, v2, 6, v11
    v_bfe_u32 v2, v1, 4, 2
    v_lshl_or_b32 v11, v2, 4, v11
    s_lshl_b32 s78, s93, 12
    s_bfe_u32 s97, s70, 0x20000
    s_lshl_b32 s97, s97, 10
    s_add_u32 s78, s78, s97
    s_lshl_b32 s97, s68, 8
    s_add_u32 s78, s78, s97
    s_add_u32 s86, s78, 0x180000
    s_bfe_u32 s79, s83, 0x30008
    s_lshl_b32 s79, s79, 18
    s_add_u32 s79, s79, 0x220000
    v_and_b32 v177, 2, v1
    v_cmp_ne_u32 s[94:95], 0, v177
    v_mov_b32 v192, 0x3f803f80
    v_mov_b32 v193, 0x3f803f80
    v_mov_b32 v194, 0x3f803f80
    v_mov_b32 v195, 0x3f803f80
    v_or_b32 v9, 2, v15
    v_or_b32 v4, 6, v15
    v_mov_b32 v144, 7
    v_mov_b32 v148, 7
    s_waitcnt vmcnt(0)
L_f_nw:
    v_lshlrev_b32 v252, 16, v252
    s_barrier
    buffer_load_dwordx4 v[144:147], v5, s[60:63], s84 offen sc1
    buffer_load_dwordx4 v[148:151], v5, s[60:63], s85 offen sc1
    ds_read_b32 v176, v14 offset:1024
    ds_read_b64_tr_b16 v[16:17], v8 offset:28672
    ds_read_b64_tr_b16 v[18:19], v8 offset:29184
    ds_read_b64_tr_b16 v[32:33], v8 offset:45056
    ds_read_b64_tr_b16 v[34:35], v8 offset:45568
    ds_read_b64_tr_b16 v[20:21], v8 offset:32768
    ds_read_b64_tr_b16 v[22:23], v8 offset:33280
    ds_read_b64_tr_b16 v[36:37], v8 offset:49152
    ds_read_b64_tr_b16 v[38:39], v8 offset:49664
    ds_read_b64_tr_b16 v[24:25], v8 offset:36864
    ds_read_b64_tr_b16 v[26:27], v8 offset:37376
    ds_read_b64_tr_b16 v[40:41], v8 offset:53248
    ds_read_b64_tr_b16 v[42:43], v8 offset:53760
    ds_read_b64_tr_b16 v[28:29], v8 offset:40960
    ds_read_b64_tr_b16 v[30:31], v8 offset:41472
    ds_read_b64_tr_b16 v[44:45], v8 offset:57344
    ds_read_b64_tr_b16 v[46:47], v8 offset:57856
    s_waitcnt lgkmcnt(0)
    v_readfirstlane_b32 s92, v176
    s_cmp_eq_u32 s92, 2
    s_cselect_b32 s79, 0x1e0000, s79
    s_add_u32 s78, s78, s79
    v_mfma_f32_16x16x32_bf16 v[208:211], v[16:19], v[192:195], 0
    v_mfma_f32_16x16x32_bf16 v[212:215], v[32:35], v[192:195], 0
    v_mfma_f32_16x16x32_bf16 v[208:211], v[20:23], v[192:195], v[208:211]
    v_mfma_f32_16x16x32_bf16 v[212:215], v[36:39], v[192:195], v[212:215]
    v_mfma_f32_16x16x32_bf16 v[208:211], v[24:27], v[192:195], v[208:211]
    v_mfma_f32_16x16x32_bf16 v[212:215], v[40:43], v[192:195], v[212:215]
    v_mfma_f32_16x16x32_bf16 v[208:211], v[28:31], v[192:195], v[208:211]
    v_mfma_f32_16x16x32_bf16 v[212:215], v[44:47], v[192:195], v[212:215]
    s_nop 7
    v_cndmask_b32 v96, v208, v212, s[94:95]
    v_and_or_b32 v96, v96, s77, v15
    v_cndmask_b32 v97, v209, v213, s[94:95]
    v_and_or_b32 v97, v97, s77, v15
    v_cndmask_b32 v98, v210, v214, s[94:95]
    v_and_or_b32 v98, v98, s77, v15
    v_cndmask_b32 v99, v211, v215, s[94:95]
    v_and_or_b32 v99, v99, s77, v15
    s_mov_b32 exec_lo, 0xf000f
    s_mov_b32 exec_hi, 0xf000f
    s_cmp_lg_u32 s92, 2
    s_cbranch_scc1 L_ls3
    buffer_store_dwordx4 v[96:99], v11, s[60:63], s86 offen
L_le3:
    s_mov_b64 exec, -1
    buffer_load_dwordx4 v[144:147], v5, s[60:63], s84 offen sc1
    buffer_load_dwordx4 v[148:151], v5, s[60:63], s85 offen sc1
    s_waitcnt vmcnt(3)
    s_branch L_pg_chk
L_pg_retry:
    s_mov_b64 exec, vcc
    buffer_load_dwordx4 v[144:147], v5, s[60:63], s84 offen sc1
    buffer_load_dwordx4 v[148:151], v5, s[60:63], s85 offen sc1
    s_mov_b64 exec, -1
    s_sub_u32 s82, s82, 1
    s_cmp_lt_i32 s82, 0
    s_cbranch_scc1 L_pg_ok
    s_waitcnt vmcnt(2)
L_pg_chk:
    v_bitop3_b32 v176, v145, v146, s73 bitop3:0x7e
    v_bitop3_b32 v177, v144, v147, s73 bitop3:0x7e
    v_bitop3_b32 v178, v149, v150, s73 bitop3:0x7e
    v_bitop3_b32 v179, v148, v151, s73 bitop3:0x7e
    v_add_f32_dpp v80, v144, v144 row_ror:8 row_mask:0xf bank_mask:0x3
    v_add_f32_dpp v81, v145, v145 row_ror:8 row_mask:0xf bank_mask:0x3
    v_add_f32_dpp v82, v146, v146 row_ror:8 row_mask:0xf bank_mask:0x3
    v_add_f32_dpp v83, v147, v147 row_ror:8 row_mask:0xf bank_mask:0x3
    v_add_f32_dpp v80, v148, v148 row_ror:8 row_mask:0xf bank_mask:0xc
    v_add_f32_dpp v81, v149, v149 row_ror:8 row_mask:0xf bank_mask:0xc
    v_add_f32_dpp v82, v150, v150 row_ror:8 row_mask:0xf bank_mask:0xc
    v_add_f32_dpp v83, v151, v151 row_ror:8 row_mask:0xf bank_mask:0xc
    v_permlane32_swap_b32 v80, v81
    v_or3_b32 v176, v176, v177, v178
    v_permlane32_swap_b32 v82, v83
    v_add_f32 v80, v80, v81
    v_add_f32 v82, v82, v83
    v_bitop3_b32 v179, v179, v176, s77 bitop3:0x54
    v_cmp_ne_u32 vcc, 0, v179
    v_permlane16_swap_b32 v80, v82
    v_add_f32 v80, v80, v82
    s_cbranch_vccnz L_pg_retry
L_pg_ok:
    v_cvt_pk_bf16_f32 v80, v80, v80
    v_and_b32 v80, s76, v80
    v_add_f32 v80, v80, v252
    v_cvt_pk_bf16_f32 v80, v80, v80
    ds_write_b16 v6, v80 offset:0
    s_waitcnt lgkmcnt(0)
    s_barrier
    ds_read_b128 v[192:195], v7 offset:0
    ds_read_b128 v[196:199], v7 offset:64
    ds_read_b128 v[200:203], v7 offset:128
    ds_read_b128 v[204:207], v7 offset:192
    s_waitcnt lgkmcnt(3)
    v_mfma_f32_16x16x32_bf16 v[208:211], v[16:19], v[192:195], 0
    v_mfma_f32_16x16x32_bf16 v[212:215], v[32:35], v[192:195], 0
    s_waitcnt lgkmcnt(2)
    v_mfma_f32_16x16x32_bf16 v[208:211], v[20:23], v[196:199], v[208:211]
    v_mfma_f32_16x16x32_bf16 v[212:215], v[36:39], v[196:199], v[212:215]
    s_waitcnt lgkmcnt(1)
    v_mfma_f32_16x16x32_bf16 v[208:211], v[24:27], v[200:203], v[208:211]
    v_mfma_f32_16x16x32_bf16 v[212:215], v[40:43], v[200:203], v[212:215]
    s_waitcnt lgkmcnt(0)
    v_mfma_f32_16x16x32_bf16 v[208:211], v[28:31], v[204:207], v[208:211]
    v_mfma_f32_16x16x32_bf16 v[212:215], v[44:47], v[204:207], v[212:215]
    s_cmp_lg_u32 s92, 2
    s_nop 6
    v_cndmask_b32 v188, v208, v212, s[94:95]
    v_and_or_b32 v188, v188, s77, v4
    v_cndmask_b32 v189, v209, v213, s[94:95]
    v_and_or_b32 v189, v189, s77, v9
    v_cndmask_b32 v190, v210, v214, s[94:95]
    v_and_or_b32 v190, v190, s77, v9
    v_cndmask_b32 v191, v211, v215, s[94:95]
    v_and_or_b32 v191, v191, s77, v4
    s_mov_b32 exec_lo, 0xf000f
    s_mov_b32 exec_hi, 0xf000f
    s_cbranch_scc1 L_ls4
    buffer_store_dwordx4 v[188:191], v11, s[60:63], s78 offen
L_le4:
    s_mov_b64 exec, -1
    s_branch L_fin
L_fd_retry:
    ds_read_b128 v[176:179], v14 offset:1248
    s_waitcnt lgkmcnt(0)
    v_min3_u32 v176, v176, v177, v178
    v_cmp_eq_u32 vcc, 0, v176
    s_cbranch_vccz L_fd_ok
    s_sleep 1
    s_sub_u32 s82, s82, 1
    s_cmp_ge_i32 s82, 0
    s_cbranch_scc1 L_fd_retry
L_fd_ok:
    ds_read_b64_tr_b16 v[48:49], v10 offset:0
    ds_read_b64_tr_b16 v[50:51], v10 offset:1024
    ds_read_b64_tr_b16 v[52:53], v10 offset:64
    ds_read_b64_tr_b16 v[54:55], v10 offset:1088
    ds_read_b64_tr_b16 v[56:57], v10 offset:8192
    ds_read_b64_tr_b16 v[58:59], v10 offset:9216
    ds_read_b64_tr_b16 v[60:61], v10 offset:8256
    ds_read_b64_tr_b16 v[62:63], v10 offset:9280
L_f_b2:
    s_barrier
    ds_read_b128 v[192:195], v3 offset:512
    ds_read_b128 v[196:199], v3 offset:576
    s_waitcnt lgkmcnt(1)
    v_mfma_f32_16x16x32_bf16 v[216:219], v[48:51], v[192:195], 0
    v_mfma_f32_16x16x32_bf16 v[220:223], v[52:55], v[192:195], 0
    s_waitcnt lgkmcnt(0)
    v_mfma_f32_16x16x32_bf16 v[216:219], v[56:59], v[196:199], v[216:219]
    v_mfma_f32_16x16x32_bf16 v[220:223], v[60:63], v[196:199], v[220:223]
    s_nop 7
    v_cndmask_b32 v184, v216, v220, s[94:95]
    v_and_or_b32 v184, v184, s77, v15
    v_cndmask_b32 v185, v217, v221, s[94:95]
    v_and_or_b32 v185, v185, s77, v15
    v_cndmask_b32 v186, v218, v222, s[94:95]
    v_and_or_b32 v186, v186, s77, v15
    v_cndmask_b32 v187, v219, v223, s[94:95]
    v_and_or_b32 v187, v187, s77, v15
    s_mov_b32 exec_lo, 0xff00ff
    s_mov_b32 exec_hi, 0xff00ff
    buffer_store_dwordx4 v[184:187], v12, s[60:63], s80 offen sc1
    s_branch L_fin
L_rrole:
    s_cmp_lt_u32 s68, 2
    s_cbranch_scc1 L_fin
    s_bfe_u32 s93, s70, 0x40000
    s_lshl_b32 s93, s93, 1
    s_bfe_u32 s97, s68, 0x10000
    s_add_u32 s93, s93, s97
    s_lshr_b32 s84, s93, 2
    s_lshl_b32 s84, s84, 8
    s_bfe_u32 s97, s93, 0x10000
    s_lshl_b32 s97, s97, 7
    s_add_u32 s84, s84, s97
    s_bfe_u32 s97, s93, 0x10001
    s_lshl_b32 s97, s97, 3
    s_add_u32 s84, s84, s97
    s_lshr_b32 s78, s93, 3
    s_lshl_b32 s78, s78, 14
    s_bfe_u32 s97, s93, 0x30000
    s_lshl_b32 s97, s97, 10
    s_add_u32 s78, s78, s97
    s_lshl_b32 s97, s72, 13
    s_add_u32 s78, s78, s97
    s_bfe_u32 s97, s69, 0x10003
    s_lshl_b32 s97, s97, 16
    s_add_u32 s78, s78, s97
    s_add_u32 s78, s78, 0x120000
    s_lshr_b32 s79, s93, 1
    s_lshl_b32 s79, s79, 14
    s_bfe_u32 s97, s93, 0x10000
    s_lshl_b32 s97, s97, 12
    s_add_u32 s79, s79, s97
    s_lshl_b32 s97, s72, 13
    s_add_u32 s79, s79, s97
    s_add_u32 s79, s79, 0xa0000
    v_bfe_u32 v6, v1, 2, 1
    v_lshlrev_b32 v6, 1, v6
    v_bfe_u32 v2, v1, 1, 1
    v_lshl_or_b32 v6, v2, 2, v6
    v_bfe_u32 v2, v1, 5, 1
    v_lshl_or_b32 v6, v2, 4, v6
    v_bfe_u32 v2, v1, 4, 1
    v_lshl_or_b32 v6, v2, 5, v6
    v_bfe_u32 v2, v1, 0, 1
    v_lshl_or_b32 v6, v2, 6, v6
    v_bfe_u32 v10, v1, 5, 1
    v_lshlrev_b32 v10, 1, v10
    v_bfe_u32 v2, v1, 4, 1
    v_lshl_or_b32 v10, v2, 2, v10
    v_bfe_u32 v2, v1, 0, 3
    v_lshl_or_b32 v10, v2, 4, v10
    s_bfe_u32 s80, s68, 0x10000
    s_lshl_b32 s80, s80, 8
    s_add_u32 s80, s80, 0x500
    v_lshl_add_u32 v7, v6, 1, s80
    v_lshl_add_u32 v8, v10, 1, s80
L_rg_retry:
    ds_read_b32 v176, v14 offset:1028
    s_waitcnt lgkmcnt(0)
    v_cmp_eq_u32 vcc, 0, v176
    s_cbranch_vccz L_rg_ok
    s_sleep 4
    s_sub_u32 s82, s82, 1
    s_cmp_ge_i32 s82, 0
    s_cbranch_scc1 L_rg_retry
L_rg_ok:
    buffer_load_ushort v252, v6, s[28:31], s84 offen
    s_mov_b32 exec_lo, 0xff00ff
    s_mov_b32 exec_hi, 0xff00ff
    buffer_store_short v14, v10, s[64:67], s84 offen
    s_mov_b64 exec, -1
    s_mov_b64 s[40:41], -1
L_rp_retry:
    s_mov_b64 exec, s[40:41]
    buffer_load_dwordx4 v[80:83], v5, s[60:63], s78 offen sc1
    s_mov_b64 exec, -1
    s_waitcnt vmcnt(0)
    v_bitop3_b32 v176, v81, v82, s73 bitop3:0x7e
    v_bitop3_b32 v177, v80, v83, s73 bitop3:0x7e
    v_bitop3_b32 v176, v176, v177, s77 bitop3:0x54
    v_cmp_ne_u32 s[40:41], 0, v176
    s_cmp_eq_u64 s[40:41], 0
    s_cbranch_scc1 L_rp_ok
    s_sub_u32 s82, s82, 1
    s_cmp_ge_i32 s82, 0
    s_cbranch_scc1 L_rp_retry
L_rp_ok:
    v_permlane32_swap_b32 v80, v81
    v_permlane32_swap_b32 v82, v83
    v_add_f32 v80, v80, v81
    v_add_f32 v82, v82, v83
    s_nop 1
    v_permlane16_swap_b32 v80, v82
    v_add_f32 v80, v80, v82
    s_nop 1
    v_add_f32_dpp v80, v80, v80 row_ror:8 row_mask:0xf bank_mask:0xf
    v_cvt_pk_bf16_f32 v80, v80, v80
    v_and_b32 v80, s76, v80
    v_lshlrev_b32 v252, 16, v252
    v_add_f32 v80, v80, v252
    v_cvt_pk_bf16_f32 v80, v80, v80
    v_and_b32 v80, s76, v80
    ds_write_b32 v7, v80
    ds_read_b32 v252, v8
    v_mov_b32 v28, v15
    v_mov_b32 v29, v15
    v_mov_b32 v30, v15
    v_mov_b32 v31, v15
    s_waitcnt lgkmcnt(0)
    s_cmp_lg_u32 s93, 0
    s_cbranch_scc1 L_r_noep
    s_mov_b64 exec, 0x1
    v_mov_b32 v11, s83
    buffer_store_dword v11, v14, s[60:63], 0 offen sc1
    s_mov_b64 exec, -1
    s_waitcnt vmcnt(0)
L_r_noep:
    s_cmp_lg_u32 s93, 0
    s_cbranch_scc1 L_r_nowb
    buffer_wbl2 sc1
L_r_nowb:
    buffer_load_dwordx4 v[16:19], v5, s[60:63], s79 offen sc1
    buffer_load_dwordx4 v[20:23], v5, s[60:63], s79 offen offset:1024 sc1
    buffer_load_dwordx4 v[24:27], v5, s[60:63], s79 offen offset:2048 sc1
    s_mov_b32 exec_hi, 0
    buffer_load_dwordx4 v[28:31], v5, s[60:63], s79 offen offset:3072 sc1
    s_mov_b64 exec, -1
    s_sleep 5
    s_mov_b64 vcc, -1
L_r4_retry:
    s_mov_b64 exec, vcc
    buffer_load_dwordx4 v[16:19], v5, s[60:63], s79 offen sc1
    buffer_load_dwordx4 v[20:23], v5, s[60:63], s79 offen offset:1024 sc1
    buffer_load_dwordx4 v[24:27], v5, s[60:63], s79 offen offset:2048 sc1
    s_mov_b32 exec_hi, 0
    s_or_b32 exec_lo, exec_lo, 1
    buffer_load_dwordx4 v[28:31], v5, s[60:63], s79 offen offset:3072 sc1
    s_mov_b64 exec, -1
    s_sub_u32 s82, s82, 1
    s_cmp_lt_i32 s82, 0
    s_cbranch_scc1 L_r4_ok
    s_waitcnt vmcnt(7)
L_r4_chk:
    v_bitop3_b32 v176, v17, v18, s73 bitop3:0x7e
    v_bitop3_b32 v177, v16, v19, s73 bitop3:0x7e
    s_waitcnt vmcnt(6)
    v_bitop3_b32 v178, v21, v22, s73 bitop3:0x7e
    v_bitop3_b32 v179, v20, v23, s73 bitop3:0x7e
    s_waitcnt vmcnt(5)
    v_bitop3_b32 v180, v25, v26, s73 bitop3:0x7e
    v_bitop3_b32 v181, v24, v27, s73 bitop3:0x7e
    s_waitcnt vmcnt(4)
    v_bitop3_b32 v182, v29, v30, s73 bitop3:0x7e
    v_bitop3_b32 v183, v28, v31, s73 bitop3:0x7e
    v_pk_add_f32 v[80:81], v[16:17], v[24:25]
    v_pk_add_f32 v[82:83], v[18:19], v[26:27]
    v_pk_add_f32 v[84:85], v[20:21], v[28:29]
    v_pk_add_f32 v[86:87], v[22:23], v[30:31]
    v_pk_add_f32 v[80:81], v[80:81], v[84:85]
    v_pk_add_f32 v[82:83], v[82:83], v[86:87]
    v_or3_b32 v176, v176, v177, v178
    v_permlane32_swap_b32 v80, v81
    v_permlane32_swap_b32 v82, v83
    v_add_f32 v80, v80, v81
    v_add_f32 v82, v82, v83
    v_or3_b32 v179, v179, v180, v181
    v_or3_b32 v182, v182, v183, v176
    v_permlane16_swap_b32 v80, v82
    v_add_f32 v80, v80, v82
    v_bitop3_b32 v179, v179, v182, s77 bitop3:0x54
    v_cmp_ne_u32 vcc, 0, v179
    v_add_f32_dpp v80, v80, v80 row_ror:8 row_mask:0xf bank_mask:0xf
    v_cvt_pk_bf16_f32 v80, v80, v80
    s_cbranch_vccnz L_r4_retry
L_r4_ok:
    v_and_b32 v80, s76, v80
    v_add_f32 v80, v80, v252
    v_cvt_pk_bf16_f32 v80, v80, v80
    s_mov_b32 exec_lo, 0xff00ff
    s_mov_b32 exec_hi, 0xff00ff
    buffer_store_short v80, v10, s[64:67], s84 offen
    s_branch L_fin
L_kv:
    s_and_b32 s72, s68, 3
    s_waitcnt lgkmcnt(0)
    s_mov_b32 s3, s98
    s_load_dword s83, s[26:27], 0
    s_mov_b32 s60, s26
    s_and_b32 s61, s27, 0xffff
    s_mov_b32 s62, 0x1000000
    s_mov_b32 s63, 0x20000
    s_mov_b32 s28, s4
    s_and_b32 s29, s5, 0xffff
    s_mov_b32 s30, 0x800
    s_mov_b32 s31, 0x20000
    s_mov_b32 s44, s12
    s_and_b32 s45, s13, 0xffff
    s_mov_b32 s46, 0x400000
    s_mov_b32 s47, 0x20000
    s_mov_b32 s48, s16
    s_and_b32 s49, s17, 0xffff
    s_mov_b32 s50, 0x1c0000
    s_mov_b32 s51, 0x20000
    s_mov_b32 s52, s18
    s_and_b32 s53, s19, 0xffff
    s_mov_b32 s54, 0x1c0000
    s_mov_b32 s55, 0x20000
    s_mov_b32 s56, s20
    s_and_b32 s57, s21, 0xffff
    s_mov_b32 s58, 0x1c0000
    s_mov_b32 s59, 0x20000
    s_mov_b32 s64, s22
    s_and_b32 s65, s23, 0xffff
    s_mov_b32 s66, 0x800
    s_mov_b32 s67, 0x20000
    v_mov_b32 v13, 1
    s_lshl_b32 s79, s72, 2
    v_mov_b32 v12, s79
    s_cmp_ge_u32 s72, 2
    s_cbranch_scc1 L_noprb
    s_sub_u32 s84, s84, s86
    v_mov_b32 v3, s84
    s_bfe_u32 s80, s80, 0x10000
    s_lshl_b32 s80, s80, 2
    v_mov_b32 v4, s80
    ds_write_b32 v4, v3 offset:1224
L_noprb:
    s_setprio 3
    s_lshl_b32 s80, s72, 13
    s_add_u32 s80, s80, 0x7000
    v_bfe_u32 v160, v1, 0, 4
    v_lshlrev_b32 v160, 8, v160
    v_bfe_u32 v2, v1, 0, 4
    v_lshl_or_b32 v160, v2, 4, v160
    v_bfe_u32 v3, v1, 4, 2
    v_lshlrev_b32 v3, 4, v3
    v_xor_b32 v160, v160, v3
    v_xor_b32 v161, 64, v160
    v_xor_b32 v162, 128, v160
    v_xor_b32 v163, 192, v160
    v_add_u32 v160, s80, v160
    v_add_u32 v161, s80, v161
    v_add_u32 v162, s80, v162
    v_add_u32 v163, s80, v163
    v_bfe_u32 v3, v1, 2, 2
    v_lshlrev_b32 v3, 8, v3
    v_bfe_u32 v2, v1, 4, 2
    v_lshl_or_b32 v3, v2, 4, v3
    v_add_u32 v3, 0x900, v3
    v_mov_b32 v4, 768
    v_and_b32 v6, 3, v1
    v_cmp_eq_u32 vcc, 0, v6
    s_nop 1
    v_cndmask_b32 v164, v4, v3, vcc
    v_cmp_eq_u32 vcc, 1, v6
    s_nop 1
    v_cndmask_b32 v165, v4, v3, vcc
    v_cmp_eq_u32 vcc, 2, v6
    s_nop 1
    v_cndmask_b32 v166, v4, v3, vcc
    v_cmp_eq_u32 vcc, 3, v6
    s_nop 1
    v_cndmask_b32 v167, v4, v3, vcc
    s_lshl_b32 s80, s72, 13
    s_add_u32 s80, s80, 0x17000
    v_bfe_u32 v168, v1, 2, 4
    v_lshlrev_b32 v168, 8, v168
    v_bfe_u32 v2, v1, 2, 3
    v_lshl_or_b32 v168, v2, 5, v168
    v_bfe_u32 v2, v1, 1, 1
    v_lshl_or_b32 v168, v2, 4, v168
    v_bfe_u32 v2, v1, 0, 1
    v_lshl_or_b32 v168, v2, 3, v168
    v_xor_b32 v169, 32, v168
    v_xor_b32 v170, 64, v168
    v_xor_b32 v171, 96, v168
    v_xor_b32 v172, 128, v168
    v_xor_b32 v173, 160, v168
    v_xor_b32 v174, 192, v168
    v_xor_b32 v175, 224, v168
    v_add_u32 v168, s80, v168
    v_add_u32 v169, s80, v169
    v_add_u32 v170, s80, v170
    v_add_u32 v171, s80, v171
    v_add_u32 v172, s80, v172
    v_add_u32 v173, s80, v173
    v_add_u32 v174, s80, v174
    v_add_u32 v175, s80, v175
    v_bfe_u32 v11, v1, 2, 2
    v_lshlrev_b32 v11, 4, v11
    v_add_u32 v10, v12, v11
    s_lshl_b32 s81, s72, 11
    v_add_u32 v9, s81, v5
    s_lshl_b32 s81, s72, 10
    s_add_u32 s81, s81, 0x3000
    v_add_u32 v8, s81, v5
    s_waitcnt lgkmcnt(0)
    s_add_u32 s83, s83, 8
    s_and_b32 s73, s83, 0x3f8
    v_mov_b32 v15, s73
    s_lshl_b32 s80, s72, 3
    s_add_u32 s80, s80, 0x48
L_k_retry:
    ds_read_b32 v206, v14 offset:1036
    s_waitcnt lgkmcnt(0)
    v_cmp_gt_u32 vcc, s80, v206
    s_cbranch_vccz L_k_ok
    s_sleep 4
    s_sub_u32 s82, s82, 1
    s_cmp_ge_i32 s82, 0
    s_cbranch_scc1 L_k_retry
L_k_ok:
    ds_read_b128 v[16:19], v160 offset:0
    ds_read_b128 v[20:23], v161 offset:0
    ds_read_b128 v[24:27], v162 offset:0
    ds_read_b128 v[28:31], v163 offset:0
    ds_read_b128 v[32:35], v160 offset:4096
    ds_read_b128 v[36:39], v161 offset:4096
    ds_read_b128 v[40:43], v162 offset:4096
    ds_read_b128 v[44:47], v163 offset:4096
    ds_read_b128 v[48:51], v160 offset:32768
    ds_read_b128 v[52:55], v161 offset:32768
    ds_read_b128 v[56:59], v162 offset:32768
    ds_read_b128 v[60:63], v163 offset:32768
    ds_read_b128 v[64:67], v160 offset:36864
    ds_read_b128 v[68:71], v161 offset:36864
    ds_read_b128 v[72:75], v162 offset:36864
    ds_read_b128 v[76:79], v163 offset:36864
L_qf_retry:
    ds_read_b32 v176, v14 offset:1024
    s_waitcnt lgkmcnt(0)
    v_cmp_eq_u32 vcc, 0, v176
    s_cbranch_vccz L_qf_ok
    s_sleep 2
    s_sub_u32 s82, s82, 1
    s_cmp_ge_i32 s82, 0
    s_cbranch_scc1 L_qf_retry
L_qf_ok:
    v_readfirstlane_b32 s92, v176
    ds_read_b128 v[80:83], v164 offset:0
    ds_read_b128 v[84:87], v164 offset:64
    ds_read_b128 v[88:91], v164 offset:128
    ds_read_b128 v[92:95], v164 offset:192
    ds_read_b128 v[96:99], v165 offset:0
    ds_read_b128 v[100:103], v165 offset:64
    ds_read_b128 v[104:107], v165 offset:128
    ds_read_b128 v[108:111], v165 offset:192
    ds_read_b128 v[112:115], v166 offset:0
    ds_read_b128 v[116:119], v166 offset:64
    ds_read_b128 v[120:123], v166 offset:128
    ds_read_b128 v[124:127], v166 offset:192
    ds_read_b128 v[128:131], v167 offset:0
    ds_read_b128 v[132:135], v167 offset:64
    ds_read_b128 v[136:139], v167 offset:128
    ds_read_b128 v[140:143], v167 offset:192
    s_waitcnt lgkmcnt(15)
    v_mfma_f32_16x16x32_bf16 v[176:179], v[16:19], v[80:83], 0
    s_waitcnt lgkmcnt(14)
    v_mfma_f32_16x16x32_bf16 v[176:179], v[20:23], v[84:87], v[176:179]
    s_waitcnt lgkmcnt(13)
    v_mfma_f32_16x16x32_bf16 v[176:179], v[24:27], v[88:91], v[176:179]
    s_waitcnt lgkmcnt(12)
    v_mfma_f32_16x16x32_bf16 v[176:179], v[28:31], v[92:95], v[176:179]
    s_waitcnt lgkmcnt(11)
    v_mfma_f32_16x16x32_bf16 v[176:179], v[32:35], v[96:99], v[176:179]
    s_waitcnt lgkmcnt(10)
    v_mfma_f32_16x16x32_bf16 v[176:179], v[36:39], v[100:103], v[176:179]
    s_waitcnt lgkmcnt(9)
    v_mfma_f32_16x16x32_bf16 v[176:179], v[40:43], v[104:107], v[176:179]
    s_waitcnt lgkmcnt(8)
    v_mfma_f32_16x16x32_bf16 v[176:179], v[44:47], v[108:111], v[176:179]
    s_waitcnt lgkmcnt(7)
    v_mfma_f32_16x16x32_bf16 v[176:179], v[48:51], v[112:115], v[176:179]
    s_waitcnt lgkmcnt(6)
    v_mfma_f32_16x16x32_bf16 v[176:179], v[52:55], v[116:119], v[176:179]
    s_waitcnt lgkmcnt(5)
    v_mfma_f32_16x16x32_bf16 v[176:179], v[56:59], v[120:123], v[176:179]
    s_waitcnt lgkmcnt(4)
    v_mfma_f32_16x16x32_bf16 v[176:179], v[60:63], v[124:127], v[176:179]
    s_waitcnt lgkmcnt(3)
    v_mfma_f32_16x16x32_bf16 v[176:179], v[64:67], v[128:131], v[176:179]
    s_waitcnt lgkmcnt(2)
    v_mfma_f32_16x16x32_bf16 v[176:179], v[68:71], v[132:135], v[176:179]
    s_waitcnt lgkmcnt(1)
    v_mfma_f32_16x16x32_bf16 v[176:179], v[72:75], v[136:139], v[176:179]
    s_waitcnt lgkmcnt(0)
    v_mfma_f32_16x16x32_bf16 v[176:179], v[76:79], v[140:143], v[176:179]
    s_mov_b32 s78, 0x3db504f3
    s_nop 6
    v_cvt_pk_bf16_f32 v177, v176, v177
    v_cvt_pk_bf16_f32 v179, v178, v179
    v_lshlrev_b32 v176, 16, v177
    v_and_b32 v177, s76, v177
    v_lshlrev_b32 v178, 16, v179
    v_and_b32 v179, s76, v179
    v_mul_f32 v176, s78, v176
    v_mul_f32 v177, s78, v177
    v_mul_f32 v178, s78, v178
    v_mul_f32 v179, s78, v179
    v_cvt_pk_bf16_f32 v177, v176, v177
    v_cvt_pk_bf16_f32 v179, v178, v179
    v_lshlrev_b32 v176, 16, v177
    v_and_b32 v177, s76, v177
    v_lshlrev_b32 v178, 16, v179
    v_and_b32 v179, s76, v179
    v_max3_f32 v192, v176, v177, v178
    v_max_f32 v192, v192, v179
    s_nop 1
    v_max_f32_dpp v192, v192, v192 quad_perm:[1,0,3,2] row_mask:0xf bank_mask:0xf
    s_nop 1
    v_max_f32_dpp v192, v192, v192 quad_perm:[2,3,0,1] row_mask:0xf bank_mask:0xf
    v_mov_b32 v196, v192
    s_nop 1
    v_permlane16_swap_b32 v192, v196
    v_max_f32 v192, v192, v196
    v_mov_b32 v196, v192
    s_nop 1
    v_permlane32_swap_b32 v192, v196
    v_max_f32 v192, v192, v196
    ds_write_b32 v10, v192 offset:1088
    ds_write_b32 v12, v13 offset:1056
    s_mov_b32 s78, 0x3fb8aa3b
L_sf_retry:
    ds_read_b128 v[188:191], v14 offset:1056
    ds_read_b128 v[184:187], v11 offset:1088
    s_waitcnt lgkmcnt(0)
    v_min3_u32 v188, v188, v189, v190
    v_min_u32 v188, v188, v191
    v_max3_f32 v192, v184, v185, v186
    v_cmp_eq_u32 vcc, 0, v188
    s_cbranch_vccz L_sf_ok
    s_sub_u32 s82, s82, 1
    s_cmp_ge_i32 s82, 0
    s_cbranch_scc1 L_sf_retry
L_sf_ok:
    v_max_f32 v192, v192, v187
    v_sub_f32 v176, v176, v192
    v_sub_f32 v177, v177, v192
    v_sub_f32 v178, v178, v192
    v_sub_f32 v179, v179, v192
    v_mul_f32 v176, s78, v176
    v_mul_f32 v177, s78, v177
    v_mul_f32 v178, s78, v178
    v_mul_f32 v179, s78, v179
    v_exp_f32 v176, v176
    v_exp_f32 v177, v177
    v_exp_f32 v178, v178
    v_exp_f32 v179, v179
    v_cvt_pk_bf16_f32 v180, v176, v177
    v_cvt_pk_bf16_f32 v181, v178, v179
    v_pk_add_f32 v[194:195], v[176:177], v[178:179]
    v_add_f32 v193, v194, v195
    v_mov_b32_dpp v240, v180 quad_perm:[0,0,0,0] row_mask:0xf bank_mask:0xf
    v_mov_b32_dpp v241, v181 quad_perm:[0,0,0,0] row_mask:0xf bank_mask:0xf
    v_mov_b32_dpp v242, v180 quad_perm:[1,1,1,1] row_mask:0xf bank_mask:0xf
    v_mov_b32_dpp v243, v181 quad_perm:[1,1,1,1] row_mask:0xf bank_mask:0xf
    v_mov_b32_dpp v244, v180 quad_perm:[2,2,2,2] row_mask:0xf bank_mask:0xf
    v_mov_b32_dpp v245, v181 quad_perm:[2,2,2,2] row_mask:0xf bank_mask:0xf
    v_mov_b32_dpp v246, v180 quad_perm:[3,3,3,3] row_mask:0xf bank_mask:0xf
    v_mov_b32_dpp v247, v181 quad_perm:[3,3,3,3] row_mask:0xf bank_mask:0xf
    ds_write_b128 v8, v[244:247]
    v_add_f32_dpp v193, v193, v193 quad_perm:[1,0,3,2] row_mask:0xf bank_mask:0xf
    s_nop 1
    v_add_f32_dpp v193, v193, v193 quad_perm:[2,3,0,1] row_mask:0xf bank_mask:0xf
    v_mov_b32 v196, v193
    s_nop 1
    v_permlane16_swap_b32 v193, v196
    v_add_f32 v193, v193, v196
    v_mov_b32 v196, v193
    s_nop 1
    v_permlane32_swap_b32 v193, v196
    v_add_f32 v193, v193, v196
    ds_write_b32 v10, v193 offset:1152
    ds_write_b32 v12, v13 offset:1072
    s_cmp_lg_u32 s72, 3
    s_cbranch_scc1 L_ml_skip
    s_lshl_b32 s79, s69, 12
    s_lshl_b32 s97, s70, 7
    s_add_u32 s79, s79, s97
    s_add_u32 s79, s79, 0x18000
    v_mov_b32 v194, s83
    v_mov_b32 v195, s83
L_lf_retry:
    ds_read_b128 v[188:191], v14 offset:1072
    ds_read_b128 v[184:187], v11 offset:1152
    s_waitcnt lgkmcnt(0)
    v_min3_u32 v188, v188, v189, v190
    v_min_u32 v188, v188, v191
    v_pk_add_f32 v[184:185], v[184:185], v[186:187]
    v_cmp_eq_u32 vcc, 0, v188
    s_cbranch_vccz L_lf_ok
    s_sub_u32 s82, s82, 1
    s_cmp_ge_i32 s82, 0
    s_cbranch_scc1 L_lf_retry
L_lf_ok:
    v_add_f32 v193, v184, v185
    s_mov_b64 exec, 0x1111
    s_cmp_lg_u32 s92, 2
    s_cbranch_scc1 L_ls5
    buffer_store_dwordx4 v[192:195], v11, s[60:63], s79 offen
L_le5:
    s_mov_b64 exec, -1
L_ml_skip:
    s_lshl_b32 s80, s72, 3
    s_add_u32 s80, s80, 0x68
L_v0_retry:
    ds_read_b32 v206, v14 offset:1036
    s_waitcnt lgkmcnt(0)
    v_cmp_gt_u32 vcc, s80, v206
    s_cbranch_vccz L_v0_ok
    s_sleep 2
    s_sub_u32 s82, s82, 1
    s_cmp_ge_i32 s82, 0
    s_cbranch_scc1 L_v0_retry
L_v0_ok:
    ds_read_b64_tr_b16 v[16:17], v168 offset:0
    ds_read_b64_tr_b16 v[20:21], v169 offset:0
    ds_read_b64_tr_b16 v[24:25], v170 offset:0
    ds_read_b64_tr_b16 v[28:29], v171 offset:0
    ds_read_b64_tr_b16 v[32:33], v172 offset:0
    ds_read_b64_tr_b16 v[36:37], v173 offset:0
    ds_read_b64_tr_b16 v[40:41], v174 offset:0
    ds_read_b64_tr_b16 v[44:45], v175 offset:0
    ds_read_b64_tr_b16 v[18:19], v168 offset:4096
    ds_read_b64_tr_b16 v[22:23], v169 offset:4096
    ds_read_b64_tr_b16 v[26:27], v170 offset:4096
    ds_read_b64_tr_b16 v[30:31], v171 offset:4096
    ds_read_b64_tr_b16 v[34:35], v172 offset:4096
    ds_read_b64_tr_b16 v[38:39], v173 offset:4096
    ds_read_b64_tr_b16 v[42:43], v174 offset:4096
    ds_read_b64_tr_b16 v[46:47], v175 offset:4096
    s_waitcnt lgkmcnt(7)
    v_mfma_f32_16x16x32_bf16 v[208:211], v[240:243], v[16:19], 0
    s_waitcnt lgkmcnt(6)
    v_mfma_f32_16x16x32_bf16 v[212:215], v[240:243], v[20:23], 0
    s_waitcnt lgkmcnt(5)
    v_mfma_f32_16x16x32_bf16 v[216:219], v[240:243], v[24:27], 0
    s_waitcnt lgkmcnt(4)
    v_mfma_f32_16x16x32_bf16 v[220:223], v[240:243], v[28:31], 0
    s_waitcnt lgkmcnt(3)
    v_mfma_f32_16x16x32_bf16 v[224:227], v[240:243], v[32:35], 0
    s_waitcnt lgkmcnt(2)
    v_mfma_f32_16x16x32_bf16 v[228:231], v[240:243], v[36:39], 0
    s_waitcnt lgkmcnt(1)
    v_mfma_f32_16x16x32_bf16 v[232:235], v[240:243], v[40:43], 0
    s_waitcnt lgkmcnt(0)
    v_mfma_f32_16x16x32_bf16 v[236:239], v[240:243], v[44:47], 0
    v_mov_b32 v80, v208
    v_mov_b32 v81, v212
    v_mov_b32 v82, v216
    v_mov_b32 v83, v220
    v_mov_b32 v84, v224
    v_mov_b32 v85, v228
    v_mov_b32 v86, v232
    s_nop 0
    v_mov_b32 v87, v236
    ds_write_b128 v9, v[80:83] offset:4096
    ds_write_b128 v9, v[84:87] offset:5120
    ds_write_b32 v12, v13 offset:1040
    s_mov_b32 s68, 1
    s_cmp_lg_u32 s72, 1
    s_cbranch_scc1 L_kv_nr
    s_setprio 0
    s_branch L_role_common
L_kv_nr:
    s_cmp_eq_u32 s69, 7
    s_cbranch_scc1 L_fin
    s_lshl_b32 s93, s69, 2
    s_bfe_u32 s97, s70, 0x20002
    s_add_u32 s93, s93, s97
    s_cmp_eq_u32 s72, 3
    s_cbranch_scc1 L_s_go
    s_cmp_ge_u32 s70, 16
    s_cbranch_scc1 L_fin
    s_setprio 0
    v_bfe_u32 v8, v1, 4, 2
    v_lshlrev_b32 v8, 10, v8
    v_bfe_u32 v2, v1, 0, 4
    v_lshl_or_b32 v8, v2, 4, v8
    v_add_u32 v9, 0xc00, v8
    v_add_u32 v10, 0x1800, v8
    v_add_u32 v11, 0x2400, v8
    s_lshl_b32 s85, s93, 16
    s_bfe_u32 s97, s70, 0x20000
    s_lshl_b32 s97, s97, 8
    s_add_u32 s85, s85, s97
    s_lshl_b32 s97, s72, 14
    s_add_u32 s85, s85, s97
    s_add_u32 s86, s85, 0x4000
    s_lshl_b32 s78, s72, 12
    s_add_u32 s78, s78, 0x3000
    s_mov_b32 m0, s78
    v_mov_b32 v4, 1
    v_mov_b32 v5, 1
    s_barrier
    s_barrier
    buffer_load_dwordx4 v8, s[56:59], s85 offen offset:0 nt lds
    buffer_load_dwordx4 v9, s[56:59], s85 offen offset:1024 nt lds
    buffer_load_dwordx4 v10, s[56:59], s85 offen offset:2048 nt lds
    buffer_load_dwordx4 v11, s[56:59], s85 offen offset:3072 nt lds
    s_add_u32 m0, m0, 4096
    s_nop 0
    buffer_load_dwordx4 v8, s[56:59], s86 offen offset:0 nt lds
    buffer_load_dwordx4 v9, s[56:59], s86 offen offset:1024 nt lds
    buffer_load_dwordx4 v10, s[56:59], s86 offen offset:2048 nt lds
    buffer_load_dwordx4 v11, s[56:59], s86 offen offset:3072 nt lds
    s_waitcnt vmcnt(0)
    ds_write_b64 v12, v[4:5] offset:1248
    s_branch L_fin
L_s_go:
    s_lshl_b32 s79, s93, 12
    s_add_u32 s80, s79, 0x180000
    s_bfe_u32 s78, s83, 0x30008
    s_lshl_b32 s78, s78, 18
    s_add_u32 s78, s78, 0x220000
    s_cmp_eq_u32 s92, 2
    s_cselect_b32 s78, 0x1e0000, s78
    s_add_u32 s79, s79, s78
    s_or_b32 s78, s73, 2
    s_or_b32 s84, s73, 6
    s_lshl_b32 s88, s69, 12
    s_bfe_u32 s97, s70, 0x20002
    s_lshl_b32 s97, s97, 9
    s_add_u32 s88, s88, s97
    s_add_u32 s88, s88, 0x18840
    s_bfe_u32 s81, s70, 0x20000
    s_lshl_b32 s81, s81, 7
    s_add_u32 s81, s81, s88
    v_bfe_u32 v7, v1, 0, 1
    v_lshlrev_b32 v7, 8, v7
    v_bfe_u32 v2, v1, 4, 2
    v_lshl_or_b32 v7, v2, 4, v7
    v_bfe_u32 v4, v1, 0, 2
    v_lshlrev_b32 v4, 7, v4
    v_bfe_u32 v2, v1, 2, 1
    v_lshl_or_b32 v4, v2, 4, v4
    v_bfe_u32 v13, v1, 2, 1
    v_lshlrev_b32 v13, 7, v13
    v_bfe_u32 v2, v1, 4, 2
    v_lshl_or_b32 v13, v2, 5, v13
    v_bfe_u32 v2, v1, 0, 2
    v_lshl_or_b32 v13, v2, 3, v13
    v_mov_b32 v32, 0x3f803f80
    v_mov_b32 v33, 0x3f803f80
    v_mov_b32 v34, 0x3f803f80
    v_mov_b32 v35, 0x3f803f80
    v_mov_b32 v134, v15
    v_mov_b32 v135, v15
    s_mov_b64 s[94:95], 2
    s_barrier
    s_barrier
    s_cmp_lt_u32 s70, 16
    s_cbranch_scc1 L_t_go
    ds_read_b128 v[16:19], v7 offset:0
    ds_read_b128 v[20:23], v7 offset:64
    ds_read_b128 v[24:27], v7 offset:128
    ds_read_b128 v[28:31], v7 offset:192
L_cs_early:
    s_waitcnt lgkmcnt(3)
    v_mfma_f32_16x16x32_bf16 v[212:215], v[32:35], v[16:19], 0
    v_mfma_f32_16x16x32_bf16 v[208:211], v[16:19], v[16:19], 0
    s_waitcnt lgkmcnt(2)
    v_mfma_f32_16x16x32_bf16 v[212:215], v[32:35], v[20:23], v[212:215]
    v_mfma_f32_16x16x32_bf16 v[208:211], v[20:23], v[20:23], v[208:211]
    s_waitcnt lgkmcnt(1)
    v_mfma_f32_16x16x32_bf16 v[212:215], v[32:35], v[24:27], v[212:215]
    v_mfma_f32_16x16x32_bf16 v[208:211], v[24:27], v[24:27], v[208:211]
    s_waitcnt lgkmcnt(0)
    v_mfma_f32_16x16x32_bf16 v[212:215], v[32:35], v[28:31], v[212:215]
    v_mfma_f32_16x16x32_bf16 v[208:211], v[28:31], v[28:31], v[208:211]
    s_cmp_lg_u32 s92, 2
    s_nop 5
    v_and_or_b32 v132, v212, s77, v15
    v_cndmask_b32 v133, v208, v209, s[94:95]
    v_and_or_b32 v133, v133, s77, v15
    s_mov_b64 exec, 0x3
    s_cbranch_scc1 L_ls6
    buffer_store_dwordx4 v[132:135], v5, s[60:63], s81 offen
L_le6:
    s_mov_b64 exec, -1
    s_branch L_fin
L_t_go:
    s_mov_b64 s[40:41], -1
L_cs_retry:
    s_mov_b64 exec, s[40:41]
    buffer_load_dwordx4 v[160:163], v5, s[60:63], s80 offen sc1
    buffer_load_dwordx4 v[164:167], v5, s[60:63], s80 offen offset:1024 sc1
    buffer_load_dwordx4 v[168:171], v5, s[60:63], s80 offen offset:2048 sc1
    buffer_load_dwordx4 v[172:175], v5, s[60:63], s80 offen offset:3072 sc1
    s_mov_b64 exec, -1
    s_waitcnt vmcnt(0)
    v_bitop3_b32 v176, v161, v162, s73 bitop3:0x7e
    v_bitop3_b32 v177, v160, v163, s73 bitop3:0x7e
    v_bitop3_b32 v178, v165, v166, s73 bitop3:0x7e
    v_bitop3_b32 v179, v164, v167, s73 bitop3:0x7e
    v_bitop3_b32 v180, v169, v170, s73 bitop3:0x7e
    v_bitop3_b32 v181, v168, v171, s73 bitop3:0x7e
    v_bitop3_b32 v182, v173, v174, s73 bitop3:0x7e
    v_bitop3_b32 v183, v172, v175, s73 bitop3:0x7e
    v_or3_b32 v176, v176, v177, v178
    v_or3_b32 v179, v179, v180, v181
    v_or3_b32 v182, v182, v183, v176
    v_bitop3_b32 v179, v179, v182, s77 bitop3:0x54
    v_cmp_ne_u32 s[40:41], 0, v179
    s_cmp_eq_u64 s[40:41], 0
    s_cbranch_scc1 L_cs_ok
    s_sub_u32 s82, s82, 1
    s_cmp_ge_i32 s82, 0
    s_cbranch_scc1 L_cs_retry
L_cs_ok:
    v_pk_add_f32 v[112:113], v[160:161], v[168:169]
    v_pk_add_f32 v[114:115], v[162:163], v[170:171]
    v_pk_add_f32 v[116:117], v[164:165], v[172:173]
    v_pk_add_f32 v[118:119], v[166:167], v[174:175]
    v_pk_add_f32 v[112:113], v[112:113], v[116:117]
    v_pk_add_f32 v[114:115], v[114:115], v[118:119]
    buffer_load_dwordx4 v[128:131], v4, s[60:63], s88 offen sc1
    buffer_load_dwordx4 v[144:147], v5, s[60:63], s79 offen sc1
    buffer_load_dwordx4 v[148:151], v5, s[60:63], s79 offen offset:1024 sc1
    buffer_load_dwordx4 v[152:155], v5, s[60:63], s79 offen offset:2048 sc1
    buffer_load_dwordx4 v[156:159], v5, s[60:63], s79 offen offset:3072 sc1
    s_sleep 2
    s_mov_b64 vcc, -1
L_gu_retry:
    s_mov_b64 exec, vcc
    buffer_load_dwordx4 v[128:131], v4, s[60:63], s88 offen sc1
    buffer_load_dwordx4 v[144:147], v5, s[60:63], s79 offen sc1
    buffer_load_dwordx4 v[148:151], v5, s[60:63], s79 offen offset:1024 sc1
    buffer_load_dwordx4 v[152:155], v5, s[60:63], s79 offen offset:2048 sc1
    buffer_load_dwordx4 v[156:159], v5, s[60:63], s79 offen offset:3072 sc1
    s_mov_b64 exec, -1
    s_sub_u32 s82, s82, 1
    s_cmp_lt_i32 s82, 0
    s_cbranch_scc1 L_gu_ok
    s_waitcnt vmcnt(9)
L_gu_chk:
    v_bitop3_b32 v176, v129, v130, s73 bitop3:0x7e
    v_bitop3_b32 v177, v128, v131, s73 bitop3:0x7e
    s_waitcnt vmcnt(8)
    v_bitop3_b32 v178, v145, v146, s78 bitop3:0x7e
    v_bitop3_b32 v179, v144, v147, s84 bitop3:0x7e
    s_waitcnt vmcnt(7)
    v_bitop3_b32 v180, v149, v150, s78 bitop3:0x7e
    v_bitop3_b32 v181, v148, v151, s84 bitop3:0x7e
    s_waitcnt vmcnt(6)
    v_bitop3_b32 v182, v153, v154, s78 bitop3:0x7e
    v_bitop3_b32 v183, v152, v155, s84 bitop3:0x7e
    s_waitcnt vmcnt(5)
    v_bitop3_b32 v184, v157, v158, s78 bitop3:0x7e
    v_bitop3_b32 v185, v156, v159, s84 bitop3:0x7e
    v_or3_b32 v176, v176, v177, v178
    v_or3_b32 v179, v179, v180, v181
    v_or3_b32 v182, v182, v183, v184
    v_or3_b32 v185, v185, v176, v179
    v_bitop3_b32 v182, v182, v185, s77 bitop3:0x54
    v_cmp_ne_u32 vcc, 0, v182
    v_add_f32_dpp v132, v128, v128 quad_perm:[1,0,3,2] row_mask:0xf bank_mask:0xf
    v_add_f32_dpp v133, v129, v129 quad_perm:[1,0,3,2] row_mask:0xf bank_mask:0xf
    s_cbranch_vccnz L_gu_retry
L_gu_ok:
    v_pk_add_f32 v[96:97], v[144:145], v[152:153]
    v_add_f32_dpp v132, v132, v132 quad_perm:[2,3,0,1] row_mask:0xf bank_mask:0xf
    v_add_f32_dpp v133, v133, v133 quad_perm:[2,3,0,1] row_mask:0xf bank_mask:0xf
    v_pk_add_f32 v[98:99], v[146:147], v[154:155]
    v_mul_f32 v132, 0x3b000000, v132
    v_mul_f32 v133, 0x3b000000, v133
    v_fma_f32 v133, -v132, v132, v133
    v_max_f32 v133, 0, v133
    v_cvt_pk_bf16_f32 v134, v132, v133
    v_and_b32 v133, s76, v134
    v_add_f32 v133, 0x3727c5ac, v133
    v_cvt_pk_bf16_f32 v133, v133, v133
    v_and_b32 v133, s76, v133
    v_sqrt_f32 v133, v133
    v_pk_add_f32 v[100:101], v[148:149], v[156:157]
    v_lshlrev_b32 v132, 16, v134
    v_cvt_pk_bf16_f32 v133, v133, v133
    v_and_b32 v133, s76, v133
    v_rcp_f32 v133, v133
    v_pk_add_f32 v[102:103], v[150:151], v[158:159]
    v_mul_f32 v134, v132, v133
    v_mov_b32 v132, v133
    v_pk_add_f32 v[96:97], v[96:97], v[100:101]
    v_pk_add_f32 v[98:99], v[98:99], v[102:103]
    v_mul_f32 v120, -v134, v112
    v_mul_f32 v121, -v134, v113
    v_mul_f32 v122, -v134, v114
    v_mul_f32 v123, -v134, v115
    v_pk_fma_f32 v[96:97], v[96:97], v[132:133], v[120:121]
    v_pk_fma_f32 v[98:99], v[98:99], v[132:133], v[122:123]
    v_cvt_pk_bf16_f32 v97, v96, v97
    v_cvt_pk_bf16_f32 v99, v98, v99
    v_lshlrev_b32 v96, 16, v97
    v_and_b32 v97, s76, v97
    v_lshlrev_b32 v98, 16, v99
    v_and_b32 v99, s76, v99
    v_mul_f32_dpp v100, v96, v96 row_ror:8 row_mask:0xf bank_mask:0xf
    v_mul_f32_dpp v101, v97, v97 row_ror:8 row_mask:0xf bank_mask:0xf
    v_mul_f32_dpp v102, v98, v98 row_ror:8 row_mask:0xf bank_mask:0xf
    v_mul_f32_dpp v103, v99, v99 row_ror:8 row_mask:0xf bank_mask:0xf
    v_cvt_pk_bf16_f32 v104, v100, v101
    v_cvt_pk_bf16_f32 v105, v102, v103
    ds_write_b64 v13, v[104:105] offset:512
    s_waitcnt lgkmcnt(0)
    s_barrier
    s_branch L_fin
L_ls1:
    s_nop 1
    buffer_store_dwordx4 v[80:83], v4, s[60:63], s88 offen sc1
    buffer_store_dwordx4 v[84:87], v4, s[60:63], s89 offen sc1
    s_branch L_le1
L_ls2:
    s_nop 1
    buffer_store_dwordx4 v[184:187], v12, s[60:63], s80 offen sc1
    s_branch L_le2
L_ls3:
    s_nop 1
    buffer_store_dwordx4 v[96:99], v11, s[60:63], s86 offen sc1
    s_branch L_le3
L_ls4:
    s_nop 1
    buffer_store_dwordx4 v[188:191], v11, s[60:63], s78 offen sc1
    s_branch L_le4
L_ls5:
    s_nop 1
    buffer_store_dwordx4 v[192:195], v11, s[60:63], s79 offen sc1
    s_branch L_le5
L_ls6:
    s_nop 1
    buffer_store_dwordx4 v[132:135], v5, s[60:63], s81 offen sc1
    s_branch L_le6
L_fin:
L_end:
    s_endpgm
.section .rodata,"a"
.p2align 6
.amdhsa_kernel sequential_preLN__sliding_block_cached__glu_gated_bilinear__decode_kernel
  .amdhsa_next_free_vgpr 256
  .amdhsa_next_free_sgpr 102
  .amdhsa_accum_offset 256
  .amdhsa_group_segment_fixed_size 0
  .amdhsa_kernarg_size 96
  .amdhsa_user_sgpr_count 2
  .amdhsa_user_sgpr_kernarg_segment_ptr 1
  .amdhsa_system_sgpr_workgroup_id_x 1
.end_amdhsa_kernel
```
